```python
import torch

def _softmax(x, axis=-1):
    return torch.softmax(x, dim=axis)
def _gelu(x):
    return torch.nn.functional.gelu(x, approximate="tanh")
def _silu(x):
    return torch.nn.functional.silu(x)
def _sigmoid(x):
    return torch.sigmoid(x)
def _layernorm(x, axis=-1, eps=1e-5):
    m = x.mean(dim=axis, keepdim=True)
    v = x.var(dim=axis, keepdim=True, unbiased=False)
    return (x - m) / torch.sqrt(v + eps)
def _scatter_add(tgt, idx, src, axis=0):
    return tgt.clone().index_add_(axis, idx, src)
def _segment_sum(src, seg, n):
    out = torch.zeros((n,) + src.shape[1:], dtype=src.dtype)
    return out.index_add_(0, seg, src)
def _pad(x, pw):
    flat = tuple(v for pair in reversed(pw) for v in pair)
    return torch.nn.functional.pad(x, flat)

kernel_name = 'recurrent_scan__ssm_conv_s4__mixer_channel_mlp__prompt'

def setup_inputs():

    _w = (lambda a: (lambda t: t.to(torch.bfloat16) if t.is_floating_point() else t)(torch.as_tensor(a)))
    def _A_setup():
        B, L, D, N = 1, 2048, 512, 128
        A_re = -(lambda _x: torch.exp(torch.as_tensor(_x)))((lambda *s: torch.randn(*s, dtype=torch.bfloat16) * 3.2)(D, N))
        A_im = torch.pi * (lambda *s: torch.randn(*s, dtype=torch.bfloat16) * 0.05)(D, N)
        B_re = (lambda *s: torch.randn(*s, dtype=torch.bfloat16) * 0.1)(D, N)
        B_im = (lambda *s: torch.randn(*s, dtype=torch.bfloat16) * 0.1)(D, N)
        C_re = (lambda *s: torch.randn(*s, dtype=torch.bfloat16) * 0.1)(D, N)
        C_im = (lambda *s: torch.randn(*s, dtype=torch.bfloat16) * 0.2)(D, N)
        log_dt = (lambda *s: torch.randn(*s, dtype=torch.bfloat16) * 0.05)(D) * 0.5 - 4.0
        Dskip = (lambda *s: torch.randn(*s, dtype=torch.bfloat16) * 0.05)(D)
        return {
            "u": _w((lambda *s: torch.randn(*s, dtype=torch.bfloat16) * 0.05)(B, L, D)),
            "A_re": _w(A_re),
            "A_im": _w(A_im),
            "B_re": _w(B_re),
            "B_im": _w(B_im),
            "C_re": _w(C_re),
            "C_im": _w(C_im),
            "log_dt": _w(log_dt),
            "Dskip": _w(Dskip),
        }
    _A_in = _A_setup()

    def _B_setup():
        B, S, D, F = 1, 2048, 512, 1792
        return {
            "x": _w((lambda *s: torch.randn(*s, dtype=torch.bfloat16) * 0.05)(B, S, D)),
            "w1": _w((lambda *s: torch.randn(*s, dtype=torch.bfloat16) * 1.6)(D, F) * (D ** -0.5)),
            "b1": _w((lambda *s: torch.randn(*s, dtype=torch.bfloat16) * 0.8)(F)),
            "w2": _w((lambda *s: torch.randn(*s, dtype=torch.bfloat16) * 0.05)(F, D) * (F ** -0.5)),
            "b2": _w((lambda *s: torch.randn(*s, dtype=torch.bfloat16) * 0.05)(D)),
        }
    _B_in = _B_setup()

    return {
        "A_u": _A_in["u"],
        "A_A_re": _A_in["A_re"],
        "A_A_im": _A_in["A_im"],
        "A_B_re": _A_in["B_re"],
        "A_B_im": _A_in["B_im"],
        "A_C_re": _A_in["C_re"],
        "A_C_im": _A_in["C_im"],
        "A_log_dt": _A_in["log_dt"],
        "A_Dskip": _A_in["Dskip"],
        "B_x": _B_in["x"],
        "B_w1": _B_in["w1"],
        "B_b1": _B_in["b1"],
        "B_w2": _B_in["w2"],
        "B_b2": _B_in["b2"],
    }

def reference(A_u, A_A_re, A_A_im, A_B_re, A_B_im, A_C_re, A_C_im, A_log_dt, A_Dskip, B_x, B_w1, B_b1, B_w2, B_b2):
    def _A_ref(u, A_re, A_im, B_re, B_im, C_re, C_im, log_dt, Dskip):
        Bsz, L, D = u.shape
        dt = torch.exp(log_dt)[:, None]
        A = A_re + 1j * A_im
        Bc = B_re + 1j * B_im
        Cc = C_re + 1j * C_im
        logdA = dt * A
        dB = dt * Bc
        l = (lambda x, dt: x.to(dt))(torch.arange(L), A_re.dtype)
        P = torch.exp(logdA[:, :, None] * l[None, None, :])
        K = torch.einsum("dn,dnl,dn->dl", Cc, P, dB).real
        L2 = 2 * L
        Kp = _pad(K, ((0, 0), (0, L)))
        up = (lambda x, *d: x.permute(*d))(u, 0, 2, 1)
        up = _pad(up, ((0, 0), (0, 0), (0, L)))
        Kf = (lambda x, axes=(-2,-1): torch.fft.rfft2(x.float(), dim=axes))(Kp[:, None, :], axes=(-2, -1))
        Uf = (lambda x, axes=(-2,-1): torch.fft.rfft2(x.float(), dim=axes))(up[:, :, None, :], axes=(-2, -1))
        Yf = Uf * Kf[None, :, :, :]
        y = (lambda x, s, axes=(-2,-1): torch.fft.irfft2(x, s=s, dim=axes).to(torch.bfloat16))(Yf, (1, L2), axes=(-2, -1))[:, :, 0, :L]
        y = (lambda x, *d: x.permute(*d))(y, 0, 2, 1) + u * Dskip[None, None, :]
        return y

    def _B_ref(x, w1, b1, w2, b2):
        y = _layernorm(x, axis=-1)
        h = _gelu(torch.einsum("bsd,df->bsf", y, w1) + b1)
        return torch.einsum("bsf,fd->bsd", h, w2) + b2

    x = A_u
    xn = _layernorm(x, axis=-1)
    s = _A_ref(xn, A_A_re, A_A_im, A_B_re, A_B_im, A_C_re, A_C_im, A_log_dt, A_Dskip)
    g = _silu(_B_ref(xn, B_w1, B_b1, B_w2, B_b2))
    return x + s * g
```

```asm
; @launch grid=(256,1,1) block=(512,1,1) lds=159904
.amdgcn_target "amdgcn-amd-amdhsa--gfx950"
.text
.globl recurrent_scan__ssm_conv_s4__mixer_channel_mlp__prompt_kernel
.p2align 8
.type recurrent_scan__ssm_conv_s4__mixer_channel_mlp__prompt_kernel,@function
recurrent_scan__ssm_conv_s4__mixer_channel_mlp__prompt_kernel:
K_start:
    s_cmp_ge_u32 s2, 256
    s_cbranch_scc1 K_end
    s_load_dwordx16 s[4:19], s[0:1], 0
    s_load_dwordx4 s[20:23], s[0:1], 80
    s_load_dwordx2 s[24:25], s[0:1], 128
    s_load_dwordx4 s[84:87], s[0:1], 96
    s_load_dwordx4 s[88:91], s[0:1], 112
    s_load_dwordx2 s[92:93], s[0:1], 64
    s_getpc_b64 s[40:41]
K_pc:
    s_sub_u32 s40, s40, K_pc-K_start
    s_subb_u32 s41, s41, 0
    s_mov_b32 s42, CODE_END-K_start
    s_mov_b32 s43, 0x00020000
    v_lshlrev_b32 v5, 7, v0
    s_and_b32 s44, s2, 0x18
    s_lshl_b32 s44, s44, 10
    v_and_b32 v5, 0x1fff, v5
    v_lshrrev_b32 v6, 6, v0
    v_lshl_add_u32 v5, v6, 15, v5
    buffer_load_dword v254, v5, s[40:43], s44 offen
    v_lshrrev_b32 v2, 6, v0
    v_and_b32 v1, 63, v0
    v_mov_b32 v3, 0
    v_readfirstlane_b32 s3, v2
    v_min_u32 v4, 35, v1
    v_lshlrev_b32 v4, 3, v4
    v_add_u32 v4, 156864, v4
    v_mov_b32 v6, 0
    v_mov_b32 v7, 0
    ds_write_b64 v4, v[6:7]
    s_mov_b32 s72, 0
    s_and_b32 s26, s2, 7
    s_lshr_b32 s27, s2, 3
    s_lshl_b32 s28, s26, 5
    s_add_u32 s28, s28, s27
    s_lshr_b32 s29, s26, 1
    s_and_b32 s30, s26, 1
    s_lshl_b32 s82, s29, 2
    s_and_b32 s31, s27, 3
    s_add_u32 s82, s82, s31
    s_lshl_b32 s83, s30, 3
    s_lshr_b32 s31, s27, 2
    s_add_u32 s83, s83, s31
    s_lshl_b32 s80, s26, 2
    s_and_b32 s31, s27, 3
    s_add_u32 s80, s80, s31
    s_lshr_b32 s81, s27, 2
    s_mul_i32 s78, s81, 7
    s_lshr_b32 s78, s78, 2
    s_waitcnt lgkmcnt(0)
    s_barrier
    s_cmp_lt_u32 s3, 4
    s_cbranch_scc1 K_gemm
    s_cmp_eq_u32 s3, 4
    s_cbranch_scc1 K_x
    s_cmp_lt_u32 s3, 7
    s_cbranch_scc1 K_kgen
    s_setprio 3
    s_mov_b32 s36, s20
    s_mov_b32 s37, s21
    s_mov_b32 s38, 1835008
    s_mov_b32 s39, 0x00020000
    v_and_b32 v2, 15, v1
    v_lshrrev_b32 v3, 4, v1
    s_mul_i32 s53, s83, 224
    s_and_b32 s53, s53, 0xffffffc0
    v_mul_u32_u24 v4, 3584, v3
    v_add_u32 v4, s53, v4
    v_lshlrev_b32 v5, 1, v3
    v_xor_b32 v5, v5, v2
    v_xor_b32 v6, 0, v5
    v_lshl_add_u32 v8, v6, 4, v4
    v_xor_b32 v6, 0, v5
    v_lshl_add_u32 v9, v6, 4, v4
    v_add_u32 v9, 13312, v9
    v_xor_b32 v6, 8, v5
    v_lshl_add_u32 v10, v6, 4, v4
    v_add_u32 v10, 26624, v10
    v_xor_b32 v6, 8, v5
    v_lshl_add_u32 v11, v6, 4, v4
    v_add_u32 v11, 39936, v11
    v_lshrrev_b32 v4, 3, v1
    v_and_b32 v6, 7, v1
    v_xor_b32 v5, v3, v6
    s_lshl_b32 s52, s82, 7
    v_add_u32 v4, s52, v4
    v_lshlrev_b32 v4, 10, v4
    v_xor_b32 v6, 0, v5
    v_lshl_add_u32 v12, v6, 4, v4
    v_xor_b32 v6, 4, v5
    v_lshl_add_u32 v13, v6, 4, v4
    v_add_u32 v13, 7168, v13
    v_xor_b32 v6, 0, v5
    v_lshl_add_u32 v14, v6, 4, v4
    v_add_u32 v14, 14336, v14
    v_xor_b32 v6, 4, v5
    v_lshl_add_u32 v15, v6, 4, v4
    v_add_u32 v15, 21504, v15
    v_mov_b32 v16, 1
    v_mov_b32 v17, 156864
    s_mov_b32 m0, 0
    s_mov_b32 s57, 0
    buffer_load_dwordx4 v8, s[36:39], s57 offen offset:0 lds
    buffer_load_dwordx4 v9, s[36:39], s57 offen offset:1024 lds
    buffer_load_dwordx4 v10, s[36:39], s57 offen offset:2048 lds
    buffer_load_dwordx4 v11, s[36:39], s57 offen offset:3072 lds
    s_mov_b32 m0, 4096
    s_mov_b32 s57, 57344
    buffer_load_dwordx4 v8, s[36:39], s57 offen offset:0 lds
    buffer_load_dwordx4 v9, s[36:39], s57 offen offset:1024 lds
    buffer_load_dwordx4 v10, s[36:39], s57 offen offset:2048 lds
    buffer_load_dwordx4 v11, s[36:39], s57 offen offset:3072 lds
    s_mov_b32 m0, 8192
    s_mov_b32 s57, 114688
    buffer_load_dwordx4 v8, s[36:39], s57 offen offset:0 lds
    buffer_load_dwordx4 v9, s[36:39], s57 offen offset:1024 lds
    buffer_load_dwordx4 v10, s[36:39], s57 offen offset:2048 lds
    buffer_load_dwordx4 v11, s[36:39], s57 offen offset:3072 lds
    s_mov_b32 m0, 12288
    s_mov_b32 s57, 172032
    buffer_load_dwordx4 v8, s[36:39], s57 offen offset:0 lds
    buffer_load_dwordx4 v9, s[36:39], s57 offen offset:1024 lds
    buffer_load_dwordx4 v10, s[36:39], s57 offen offset:2048 lds
    buffer_load_dwordx4 v11, s[36:39], s57 offen offset:3072 lds
    s_mov_b32 m0, 32768
    s_mov_b32 s57, 229376
    buffer_load_dwordx4 v8, s[36:39], s57 offen offset:0 lds
    buffer_load_dwordx4 v9, s[36:39], s57 offen offset:1024 lds
    buffer_load_dwordx4 v10, s[36:39], s57 offen offset:2048 lds
    buffer_load_dwordx4 v11, s[36:39], s57 offen offset:3072 lds
    s_mov_b32 m0, 36864
    s_mov_b32 s57, 286720
    buffer_load_dwordx4 v8, s[36:39], s57 offen offset:0 lds
    buffer_load_dwordx4 v9, s[36:39], s57 offen offset:1024 lds
    buffer_load_dwordx4 v10, s[36:39], s57 offen offset:2048 lds
    buffer_load_dwordx4 v11, s[36:39], s57 offen offset:3072 lds
    s_waitcnt vmcnt(8)
    ds_write_b32 v17, v16 offset:0
    s_mov_b32 m0, 40960
    s_mov_b32 s57, 344064
    buffer_load_dwordx4 v8, s[36:39], s57 offen offset:0 lds
    buffer_load_dwordx4 v9, s[36:39], s57 offen offset:1024 lds
    buffer_load_dwordx4 v10, s[36:39], s57 offen offset:2048 lds
    buffer_load_dwordx4 v11, s[36:39], s57 offen offset:3072 lds
    s_mov_b32 m0, 45056
    s_mov_b32 s57, 401408
    buffer_load_dwordx4 v8, s[36:39], s57 offen offset:0 lds
    buffer_load_dwordx4 v9, s[36:39], s57 offen offset:1024 lds
    buffer_load_dwordx4 v10, s[36:39], s57 offen offset:2048 lds
    buffer_load_dwordx4 v11, s[36:39], s57 offen offset:3072 lds
    s_mov_b32 s40, s22
    s_mov_b32 s41, s23
    s_mov_b32 s42, 3584
    s_mov_b32 s43, 0x00020000
    v_lshlrev_b32 v18, 2, v1
    s_mul_i32 s53, s83, 224
    s_mov_b32 m0, 159648
    s_nop 0
    buffer_load_dword v18, s[40:43], s53 offen lds
    s_mov_b32 m0, 65536
    s_mov_b32 s57, 458752
    buffer_load_dwordx4 v8, s[36:39], s57 offen offset:0 lds
    buffer_load_dwordx4 v9, s[36:39], s57 offen offset:1024 lds
    buffer_load_dwordx4 v10, s[36:39], s57 offen offset:2048 lds
    buffer_load_dwordx4 v11, s[36:39], s57 offen offset:3072 lds
    s_mov_b32 m0, 69632
    s_mov_b32 s57, 516096
    buffer_load_dwordx4 v8, s[36:39], s57 offen offset:0 lds
    buffer_load_dwordx4 v9, s[36:39], s57 offen offset:1024 lds
    buffer_load_dwordx4 v10, s[36:39], s57 offen offset:2048 lds
    buffer_load_dwordx4 v11, s[36:39], s57 offen offset:3072 lds
    s_waitcnt vmcnt(9)
    ds_write_b32 v17, v16 offset:4
    s_mov_b32 m0, 73728
    s_mov_b32 s57, 573440
    buffer_load_dwordx4 v8, s[36:39], s57 offen offset:0 lds
    buffer_load_dwordx4 v9, s[36:39], s57 offen offset:1024 lds
    buffer_load_dwordx4 v10, s[36:39], s57 offen offset:2048 lds
    buffer_load_dwordx4 v11, s[36:39], s57 offen offset:3072 lds
    s_mov_b32 m0, 77824
    s_mov_b32 s57, 630784
    buffer_load_dwordx4 v8, s[36:39], s57 offen offset:0 lds
    buffer_load_dwordx4 v9, s[36:39], s57 offen offset:1024 lds
    buffer_load_dwordx4 v10, s[36:39], s57 offen offset:2048 lds
    buffer_load_dwordx4 v11, s[36:39], s57 offen offset:3072 lds
    s_mov_b32 m0, 98304
    s_mov_b32 s57, 688128
    buffer_load_dwordx4 v8, s[36:39], s57 offen offset:0 lds
    buffer_load_dwordx4 v9, s[36:39], s57 offen offset:1024 lds
    buffer_load_dwordx4 v10, s[36:39], s57 offen offset:2048 lds
    buffer_load_dwordx4 v11, s[36:39], s57 offen offset:3072 lds
    s_mov_b32 m0, 102400
    s_mov_b32 s57, 745472
    buffer_load_dwordx4 v8, s[36:39], s57 offen offset:0 lds
    buffer_load_dwordx4 v9, s[36:39], s57 offen offset:1024 lds
    buffer_load_dwordx4 v10, s[36:39], s57 offen offset:2048 lds
    buffer_load_dwordx4 v11, s[36:39], s57 offen offset:3072 lds
    s_waitcnt vmcnt(8)
    ds_write_b32 v17, v16 offset:8
    s_mov_b32 m0, 106496
    s_mov_b32 s57, 802816
    buffer_load_dwordx4 v8, s[36:39], s57 offen offset:0 lds
    buffer_load_dwordx4 v9, s[36:39], s57 offen offset:1024 lds
    buffer_load_dwordx4 v10, s[36:39], s57 offen offset:2048 lds
    buffer_load_dwordx4 v11, s[36:39], s57 offen offset:3072 lds
    s_mov_b32 m0, 110592
    s_mov_b32 s57, 860160
    buffer_load_dwordx4 v8, s[36:39], s57 offen offset:0 lds
    buffer_load_dwordx4 v9, s[36:39], s57 offen offset:1024 lds
    buffer_load_dwordx4 v10, s[36:39], s57 offen offset:2048 lds
    buffer_load_dwordx4 v11, s[36:39], s57 offen offset:3072 lds
    ds_read_b128 v[20:23], v17 offset:32
    s_waitcnt lgkmcnt(0)
    v_min_u32 v20, v20, v21
    v_min3_u32 v20, v20, v22, v23
    v_cmp_le_u32 vcc, 1, v20
    s_cbranch_vccnz ad_1
    s_waitcnt vmcnt(0)
    ds_write_b32 v17, v16 offset:12
fr_2:
    ds_read_b128 v[20:23], v17 offset:32
    s_waitcnt lgkmcnt(0)
    v_min_u32 v20, v20, v21
    v_min3_u32 v20, v20, v22, v23
    v_cmp_le_u32 vcc, 1, v20
    s_cbranch_vccnz fr_2_d
    s_sleep 2
    s_add_u32 s72, s72, 1
    s_cmp_lt_u32 s72, 0x80000
    s_cbranch_scc1 fr_2
fr_2_d:
ad_1:
    s_mov_b32 m0, 0
    s_mov_b32 s57, 917504
    buffer_load_dwordx4 v8, s[36:39], s57 offen offset:0 lds
    buffer_load_dwordx4 v9, s[36:39], s57 offen offset:1024 lds
    buffer_load_dwordx4 v10, s[36:39], s57 offen offset:2048 lds
    buffer_load_dwordx4 v11, s[36:39], s57 offen offset:3072 lds
    s_mov_b32 m0, 4096
    s_mov_b32 s57, 974848
    buffer_load_dwordx4 v8, s[36:39], s57 offen offset:0 lds
    buffer_load_dwordx4 v9, s[36:39], s57 offen offset:1024 lds
    buffer_load_dwordx4 v10, s[36:39], s57 offen offset:2048 lds
    buffer_load_dwordx4 v11, s[36:39], s57 offen offset:3072 lds
    s_waitcnt vmcnt(8)
    ds_write_b32 v17, v16 offset:12
    s_mov_b32 m0, 8192
    s_mov_b32 s57, 1032192
    buffer_load_dwordx4 v8, s[36:39], s57 offen offset:0 lds
    buffer_load_dwordx4 v9, s[36:39], s57 offen offset:1024 lds
    buffer_load_dwordx4 v10, s[36:39], s57 offen offset:2048 lds
    buffer_load_dwordx4 v11, s[36:39], s57 offen offset:3072 lds
    s_mov_b32 m0, 12288
    s_mov_b32 s57, 1089536
    buffer_load_dwordx4 v8, s[36:39], s57 offen offset:0 lds
    buffer_load_dwordx4 v9, s[36:39], s57 offen offset:1024 lds
    buffer_load_dwordx4 v10, s[36:39], s57 offen offset:2048 lds
    buffer_load_dwordx4 v11, s[36:39], s57 offen offset:3072 lds
    ds_read_b128 v[20:23], v17 offset:32
    s_waitcnt lgkmcnt(0)
    v_min_u32 v20, v20, v21
    v_min3_u32 v20, v20, v22, v23
    v_cmp_le_u32 vcc, 2, v20
    s_cbranch_vccnz ad_3
    s_waitcnt vmcnt(0)
    ds_write_b32 v17, v16 offset:16
fr_4:
    ds_read_b128 v[20:23], v17 offset:32
    s_waitcnt lgkmcnt(0)
    v_min_u32 v20, v20, v21
    v_min3_u32 v20, v20, v22, v23
    v_cmp_le_u32 vcc, 2, v20
    s_cbranch_vccnz fr_4_d
    s_sleep 2
    s_add_u32 s72, s72, 1
    s_cmp_lt_u32 s72, 0x80000
    s_cbranch_scc1 fr_4
fr_4_d:
ad_3:
    s_mov_b32 m0, 32768
    s_mov_b32 s57, 1146880
    buffer_load_dwordx4 v8, s[36:39], s57 offen offset:0 lds
    buffer_load_dwordx4 v9, s[36:39], s57 offen offset:1024 lds
    buffer_load_dwordx4 v10, s[36:39], s57 offen offset:2048 lds
    buffer_load_dwordx4 v11, s[36:39], s57 offen offset:3072 lds
    s_mov_b32 m0, 36864
    s_mov_b32 s57, 1204224
    buffer_load_dwordx4 v8, s[36:39], s57 offen offset:0 lds
    buffer_load_dwordx4 v9, s[36:39], s57 offen offset:1024 lds
    buffer_load_dwordx4 v10, s[36:39], s57 offen offset:2048 lds
    buffer_load_dwordx4 v11, s[36:39], s57 offen offset:3072 lds
    s_waitcnt vmcnt(8)
    ds_write_b32 v17, v16 offset:16
    s_mov_b32 m0, 40960
    s_mov_b32 s57, 1261568
    buffer_load_dwordx4 v8, s[36:39], s57 offen offset:0 lds
    buffer_load_dwordx4 v9, s[36:39], s57 offen offset:1024 lds
    buffer_load_dwordx4 v10, s[36:39], s57 offen offset:2048 lds
    buffer_load_dwordx4 v11, s[36:39], s57 offen offset:3072 lds
    s_mov_b32 m0, 45056
    s_mov_b32 s57, 1318912
    buffer_load_dwordx4 v8, s[36:39], s57 offen offset:0 lds
    buffer_load_dwordx4 v9, s[36:39], s57 offen offset:1024 lds
    buffer_load_dwordx4 v10, s[36:39], s57 offen offset:2048 lds
    buffer_load_dwordx4 v11, s[36:39], s57 offen offset:3072 lds
    ds_read_b128 v[20:23], v17 offset:32
    s_waitcnt lgkmcnt(0)
    v_min_u32 v20, v20, v21
    v_min3_u32 v20, v20, v22, v23
    v_cmp_le_u32 vcc, 3, v20
    s_cbranch_vccnz ad_5
    s_waitcnt vmcnt(0)
    ds_write_b32 v17, v16 offset:20
fr_6:
    ds_read_b128 v[20:23], v17 offset:32
    s_waitcnt lgkmcnt(0)
    v_min_u32 v20, v20, v21
    v_min3_u32 v20, v20, v22, v23
    v_cmp_le_u32 vcc, 3, v20
    s_cbranch_vccnz fr_6_d
    s_sleep 2
    s_add_u32 s72, s72, 1
    s_cmp_lt_u32 s72, 0x80000
    s_cbranch_scc1 fr_6
fr_6_d:
ad_5:
    s_mov_b32 m0, 65536
    s_mov_b32 s57, 1376256
    buffer_load_dwordx4 v8, s[36:39], s57 offen offset:0 lds
    buffer_load_dwordx4 v9, s[36:39], s57 offen offset:1024 lds
    buffer_load_dwordx4 v10, s[36:39], s57 offen offset:2048 lds
    buffer_load_dwordx4 v11, s[36:39], s57 offen offset:3072 lds
    s_mov_b32 m0, 69632
    s_mov_b32 s57, 1433600
    buffer_load_dwordx4 v8, s[36:39], s57 offen offset:0 lds
    buffer_load_dwordx4 v9, s[36:39], s57 offen offset:1024 lds
    buffer_load_dwordx4 v10, s[36:39], s57 offen offset:2048 lds
    buffer_load_dwordx4 v11, s[36:39], s57 offen offset:3072 lds
    s_waitcnt vmcnt(8)
    ds_write_b32 v17, v16 offset:20
    s_mov_b32 m0, 73728
    s_mov_b32 s57, 1490944
    buffer_load_dwordx4 v8, s[36:39], s57 offen offset:0 lds
    buffer_load_dwordx4 v9, s[36:39], s57 offen offset:1024 lds
    buffer_load_dwordx4 v10, s[36:39], s57 offen offset:2048 lds
    buffer_load_dwordx4 v11, s[36:39], s57 offen offset:3072 lds
    s_mov_b32 m0, 77824
    s_mov_b32 s57, 1548288
    buffer_load_dwordx4 v8, s[36:39], s57 offen offset:0 lds
    buffer_load_dwordx4 v9, s[36:39], s57 offen offset:1024 lds
    buffer_load_dwordx4 v10, s[36:39], s57 offen offset:2048 lds
    buffer_load_dwordx4 v11, s[36:39], s57 offen offset:3072 lds
    ds_read_b128 v[20:23], v17 offset:32
    s_waitcnt lgkmcnt(0)
    v_min_u32 v20, v20, v21
    v_min3_u32 v20, v20, v22, v23
    v_cmp_le_u32 vcc, 4, v20
    s_cbranch_vccnz ad_7
    s_waitcnt vmcnt(0)
    ds_write_b32 v17, v16 offset:24
fr_8:
    ds_read_b128 v[20:23], v17 offset:32
    s_waitcnt lgkmcnt(0)
    v_min_u32 v20, v20, v21
    v_min3_u32 v20, v20, v22, v23
    v_cmp_le_u32 vcc, 4, v20
    s_cbranch_vccnz fr_8_d
    s_sleep 2
    s_add_u32 s72, s72, 1
    s_cmp_lt_u32 s72, 0x80000
    s_cbranch_scc1 fr_8
fr_8_d:
ad_7:
    s_mov_b32 m0, 98304
    s_mov_b32 s57, 1605632
    buffer_load_dwordx4 v8, s[36:39], s57 offen offset:0 lds
    buffer_load_dwordx4 v9, s[36:39], s57 offen offset:1024 lds
    buffer_load_dwordx4 v10, s[36:39], s57 offen offset:2048 lds
    buffer_load_dwordx4 v11, s[36:39], s57 offen offset:3072 lds
    s_mov_b32 m0, 102400
    s_mov_b32 s57, 1662976
    buffer_load_dwordx4 v8, s[36:39], s57 offen offset:0 lds
    buffer_load_dwordx4 v9, s[36:39], s57 offen offset:1024 lds
    buffer_load_dwordx4 v10, s[36:39], s57 offen offset:2048 lds
    buffer_load_dwordx4 v11, s[36:39], s57 offen offset:3072 lds
    s_waitcnt vmcnt(8)
    ds_write_b32 v17, v16 offset:24
    s_mov_b32 m0, 106496
    s_mov_b32 s57, 1720320
    buffer_load_dwordx4 v8, s[36:39], s57 offen offset:0 lds
    buffer_load_dwordx4 v9, s[36:39], s57 offen offset:1024 lds
    buffer_load_dwordx4 v10, s[36:39], s57 offen offset:2048 lds
    buffer_load_dwordx4 v11, s[36:39], s57 offen offset:3072 lds
    s_mov_b32 m0, 110592
    s_mov_b32 s57, 1777664
    buffer_load_dwordx4 v8, s[36:39], s57 offen offset:0 lds
    buffer_load_dwordx4 v9, s[36:39], s57 offen offset:1024 lds
    buffer_load_dwordx4 v10, s[36:39], s57 offen offset:2048 lds
    buffer_load_dwordx4 v11, s[36:39], s57 offen offset:3072 lds
    s_waitcnt vmcnt(0)
    ds_write_b32 v17, v16 offset:28
    s_mov_b32 s40, s84
    s_mov_b32 s41, s85
    s_mov_b32 s42, 1835008
    s_mov_b32 s43, 0x00020000
    v_lshrrev_b32 v4, 3, v1
    v_and_b32 v5, 7, v1
    v_bfe_u32 v6, v1, 4, 1
    v_lshlrev_b32 v6, 1, v6
    v_xor_b32 v5, v5, v6
    v_lshlrev_b32 v4, 10, v4
    s_lshl_b32 s49, s81, 7
    v_add_u32 v4, s49, v4
    v_xor_b32 v6, 0, v5
    v_lshl_add_u32 v8, v6, 4, v4
    v_xor_b32 v6, 4, v5
    v_lshl_add_u32 v9, v6, 4, v4
    v_add_u32 v9, 7168, v9
    v_xor_b32 v6, 0, v5
    v_lshl_add_u32 v10, v6, 4, v4
    v_add_u32 v10, 14336, v10
    v_xor_b32 v6, 4, v5
    v_lshl_add_u32 v11, v6, 4, v4
    v_add_u32 v11, 21504, v11
    s_setprio 1
fr_9:
    ds_read_b128 v[20:23], v17 offset:32
    s_waitcnt lgkmcnt(0)
    v_min_u32 v20, v20, v21
    v_min3_u32 v20, v20, v22, v23
    v_cmp_le_u32 vcc, 5, v20
    s_cbranch_vccnz fr_9_d
    s_sleep 2
    s_add_u32 s72, s72, 1
    s_cmp_lt_u32 s72, 0x80000
    s_cbranch_scc1 fr_9
fr_9_d:
    s_mov_b32 m0, 0
    s_add_u32 s57, s78, 0
    s_sub_u32 s77, s57, 14
    s_cmp_ge_u32 s57, 14
    s_cselect_b32 s57, s77, s57
    s_lshl_b32 s57, s57, 17
    s_add_u32 s57, s57, 0
    buffer_load_dwordx4 v8, s[40:43], s57 offen offset:0 lds
    buffer_load_dwordx4 v9, s[40:43], s57 offen offset:1024 lds
    buffer_load_dwordx4 v10, s[40:43], s57 offen offset:2048 lds
    buffer_load_dwordx4 v11, s[40:43], s57 offen offset:3072 lds
    s_mov_b32 m0, 4096
    s_add_u32 s57, s78, 1
    s_sub_u32 s77, s57, 14
    s_cmp_ge_u32 s57, 14
    s_cselect_b32 s57, s77, s57
    s_lshl_b32 s57, s57, 17
    s_add_u32 s57, s57, 0
    buffer_load_dwordx4 v8, s[40:43], s57 offen offset:0 lds
    buffer_load_dwordx4 v9, s[40:43], s57 offen offset:1024 lds
    buffer_load_dwordx4 v10, s[40:43], s57 offen offset:2048 lds
    buffer_load_dwordx4 v11, s[40:43], s57 offen offset:3072 lds
    s_mov_b32 m0, 8192
    s_add_u32 s57, s78, 2
    s_sub_u32 s77, s57, 14
    s_cmp_ge_u32 s57, 14
    s_cselect_b32 s57, s77, s57
    s_lshl_b32 s57, s57, 17
    s_add_u32 s57, s57, 0
    buffer_load_dwordx4 v8, s[40:43], s57 offen offset:0 lds
    buffer_load_dwordx4 v9, s[40:43], s57 offen offset:1024 lds
    buffer_load_dwordx4 v10, s[40:43], s57 offen offset:2048 lds
    buffer_load_dwordx4 v11, s[40:43], s57 offen offset:3072 lds
    s_mov_b32 m0, 12288
    s_add_u32 s57, s78, 3
    s_sub_u32 s77, s57, 14
    s_cmp_ge_u32 s57, 14
    s_cselect_b32 s57, s77, s57
    s_lshl_b32 s57, s57, 17
    s_add_u32 s57, s57, 0
    buffer_load_dwordx4 v8, s[40:43], s57 offen offset:0 lds
    buffer_load_dwordx4 v9, s[40:43], s57 offen offset:1024 lds
    buffer_load_dwordx4 v10, s[40:43], s57 offen offset:2048 lds
    buffer_load_dwordx4 v11, s[40:43], s57 offen offset:3072 lds
    s_mov_b32 m0, 16384
    s_add_u32 s57, s78, 4
    s_sub_u32 s77, s57, 14
    s_cmp_ge_u32 s57, 14
    s_cselect_b32 s57, s77, s57
    s_lshl_b32 s57, s57, 17
    s_add_u32 s57, s57, 0
    buffer_load_dwordx4 v8, s[40:43], s57 offen offset:0 lds
    buffer_load_dwordx4 v9, s[40:43], s57 offen offset:1024 lds
    buffer_load_dwordx4 v10, s[40:43], s57 offen offset:2048 lds
    buffer_load_dwordx4 v11, s[40:43], s57 offen offset:3072 lds
    s_mov_b32 m0, 20480
    s_add_u32 s57, s78, 5
    s_sub_u32 s77, s57, 14
    s_cmp_ge_u32 s57, 14
    s_cselect_b32 s57, s77, s57
    s_lshl_b32 s57, s57, 17
    s_add_u32 s57, s57, 0
    buffer_load_dwordx4 v8, s[40:43], s57 offen offset:0 lds
    buffer_load_dwordx4 v9, s[40:43], s57 offen offset:1024 lds
    buffer_load_dwordx4 v10, s[40:43], s57 offen offset:2048 lds
    buffer_load_dwordx4 v11, s[40:43], s57 offen offset:3072 lds
    s_mov_b32 m0, 24576
    s_add_u32 s57, s78, 6
    s_sub_u32 s77, s57, 14
    s_cmp_ge_u32 s57, 14
    s_cselect_b32 s57, s77, s57
    s_lshl_b32 s57, s57, 17
    s_add_u32 s57, s57, 0
    buffer_load_dwordx4 v8, s[40:43], s57 offen offset:0 lds
    buffer_load_dwordx4 v9, s[40:43], s57 offen offset:1024 lds
    buffer_load_dwordx4 v10, s[40:43], s57 offen offset:2048 lds
    buffer_load_dwordx4 v11, s[40:43], s57 offen offset:3072 lds
fr_10:
    ds_read_b128 v[20:23], v17 offset:32
    s_waitcnt lgkmcnt(0)
    v_min_u32 v20, v20, v21
    v_min3_u32 v20, v20, v22, v23
    v_cmp_le_u32 vcc, 6, v20
    s_cbranch_vccnz fr_10_d
    s_sleep 2
    s_add_u32 s72, s72, 1
    s_cmp_lt_u32 s72, 0x80000
    s_cbranch_scc1 fr_10
fr_10_d:
    s_mov_b32 m0, 32768
    s_add_u32 s57, s78, 0
    s_sub_u32 s77, s57, 14
    s_cmp_ge_u32 s57, 14
    s_cselect_b32 s57, s77, s57
    s_lshl_b32 s57, s57, 17
    s_add_u32 s57, s57, 32768
    buffer_load_dwordx4 v8, s[40:43], s57 offen offset:0 lds
    buffer_load_dwordx4 v9, s[40:43], s57 offen offset:1024 lds
    buffer_load_dwordx4 v10, s[40:43], s57 offen offset:2048 lds
    buffer_load_dwordx4 v11, s[40:43], s57 offen offset:3072 lds
    s_mov_b32 m0, 36864
    s_add_u32 s57, s78, 1
    s_sub_u32 s77, s57, 14
    s_cmp_ge_u32 s57, 14
    s_cselect_b32 s57, s77, s57
    s_lshl_b32 s57, s57, 17
    s_add_u32 s57, s57, 32768
    buffer_load_dwordx4 v8, s[40:43], s57 offen offset:0 lds
    buffer_load_dwordx4 v9, s[40:43], s57 offen offset:1024 lds
    buffer_load_dwordx4 v10, s[40:43], s57 offen offset:2048 lds
    buffer_load_dwordx4 v11, s[40:43], s57 offen offset:3072 lds
    s_mov_b32 m0, 40960
    s_add_u32 s57, s78, 2
    s_sub_u32 s77, s57, 14
    s_cmp_ge_u32 s57, 14
    s_cselect_b32 s57, s77, s57
    s_lshl_b32 s57, s57, 17
    s_add_u32 s57, s57, 32768
    buffer_load_dwordx4 v8, s[40:43], s57 offen offset:0 lds
    buffer_load_dwordx4 v9, s[40:43], s57 offen offset:1024 lds
    buffer_load_dwordx4 v10, s[40:43], s57 offen offset:2048 lds
    buffer_load_dwordx4 v11, s[40:43], s57 offen offset:3072 lds
    s_mov_b32 m0, 45056
    s_add_u32 s57, s78, 3
    s_sub_u32 s77, s57, 14
    s_cmp_ge_u32 s57, 14
    s_cselect_b32 s57, s77, s57
    s_lshl_b32 s57, s57, 17
    s_add_u32 s57, s57, 32768
    buffer_load_dwordx4 v8, s[40:43], s57 offen offset:0 lds
    buffer_load_dwordx4 v9, s[40:43], s57 offen offset:1024 lds
    buffer_load_dwordx4 v10, s[40:43], s57 offen offset:2048 lds
    buffer_load_dwordx4 v11, s[40:43], s57 offen offset:3072 lds
    s_mov_b32 m0, 49152
    s_add_u32 s57, s78, 4
    s_sub_u32 s77, s57, 14
    s_cmp_ge_u32 s57, 14
    s_cselect_b32 s57, s77, s57
    s_lshl_b32 s57, s57, 17
    s_add_u32 s57, s57, 32768
    buffer_load_dwordx4 v8, s[40:43], s57 offen offset:0 lds
    buffer_load_dwordx4 v9, s[40:43], s57 offen offset:1024 lds
    buffer_load_dwordx4 v10, s[40:43], s57 offen offset:2048 lds
    buffer_load_dwordx4 v11, s[40:43], s57 offen offset:3072 lds
    s_mov_b32 m0, 53248
    s_add_u32 s57, s78, 5
    s_sub_u32 s77, s57, 14
    s_cmp_ge_u32 s57, 14
    s_cselect_b32 s57, s77, s57
    s_lshl_b32 s57, s57, 17
    s_add_u32 s57, s57, 32768
    buffer_load_dwordx4 v8, s[40:43], s57 offen offset:0 lds
    buffer_load_dwordx4 v9, s[40:43], s57 offen offset:1024 lds
    buffer_load_dwordx4 v10, s[40:43], s57 offen offset:2048 lds
    buffer_load_dwordx4 v11, s[40:43], s57 offen offset:3072 lds
    s_mov_b32 m0, 57344
    s_add_u32 s57, s78, 6
    s_sub_u32 s77, s57, 14
    s_cmp_ge_u32 s57, 14
    s_cselect_b32 s57, s77, s57
    s_lshl_b32 s57, s57, 17
    s_add_u32 s57, s57, 32768
    buffer_load_dwordx4 v8, s[40:43], s57 offen offset:0 lds
    buffer_load_dwordx4 v9, s[40:43], s57 offen offset:1024 lds
    buffer_load_dwordx4 v10, s[40:43], s57 offen offset:2048 lds
    buffer_load_dwordx4 v11, s[40:43], s57 offen offset:3072 lds
    s_waitcnt vmcnt(28)
    ds_write_b32 v17, v16 offset:64
fr_11:
    ds_read_b128 v[20:23], v17 offset:32
    s_waitcnt lgkmcnt(0)
    v_min_u32 v20, v20, v21
    v_min3_u32 v20, v20, v22, v23
    v_cmp_le_u32 vcc, 7, v20
    s_cbranch_vccnz fr_11_d
    s_sleep 2
    s_add_u32 s72, s72, 1
    s_cmp_lt_u32 s72, 0x80000
    s_cbranch_scc1 fr_11
fr_11_d:
    s_mov_b32 m0, 65536
    s_add_u32 s57, s78, 0
    s_sub_u32 s77, s57, 14
    s_cmp_ge_u32 s57, 14
    s_cselect_b32 s57, s77, s57
    s_lshl_b32 s57, s57, 17
    s_add_u32 s57, s57, 65536
    buffer_load_dwordx4 v8, s[40:43], s57 offen offset:0 lds
    buffer_load_dwordx4 v9, s[40:43], s57 offen offset:1024 lds
    buffer_load_dwordx4 v10, s[40:43], s57 offen offset:2048 lds
    buffer_load_dwordx4 v11, s[40:43], s57 offen offset:3072 lds
    s_mov_b32 m0, 69632
    s_add_u32 s57, s78, 1
    s_sub_u32 s77, s57, 14
    s_cmp_ge_u32 s57, 14
    s_cselect_b32 s57, s77, s57
    s_lshl_b32 s57, s57, 17
    s_add_u32 s57, s57, 65536
    buffer_load_dwordx4 v8, s[40:43], s57 offen offset:0 lds
    buffer_load_dwordx4 v9, s[40:43], s57 offen offset:1024 lds
    buffer_load_dwordx4 v10, s[40:43], s57 offen offset:2048 lds
    buffer_load_dwordx4 v11, s[40:43], s57 offen offset:3072 lds
    s_mov_b32 m0, 73728
    s_add_u32 s57, s78, 2
    s_sub_u32 s77, s57, 14
    s_cmp_ge_u32 s57, 14
    s_cselect_b32 s57, s77, s57
    s_lshl_b32 s57, s57, 17
    s_add_u32 s57, s57, 65536
    buffer_load_dwordx4 v8, s[40:43], s57 offen offset:0 lds
    buffer_load_dwordx4 v9, s[40:43], s57 offen offset:1024 lds
    buffer_load_dwordx4 v10, s[40:43], s57 offen offset:2048 lds
    buffer_load_dwordx4 v11, s[40:43], s57 offen offset:3072 lds
    s_mov_b32 m0, 77824
    s_add_u32 s57, s78, 3
    s_sub_u32 s77, s57, 14
    s_cmp_ge_u32 s57, 14
    s_cselect_b32 s57, s77, s57
    s_lshl_b32 s57, s57, 17
    s_add_u32 s57, s57, 65536
    buffer_load_dwordx4 v8, s[40:43], s57 offen offset:0 lds
    buffer_load_dwordx4 v9, s[40:43], s57 offen offset:1024 lds
    buffer_load_dwordx4 v10, s[40:43], s57 offen offset:2048 lds
    buffer_load_dwordx4 v11, s[40:43], s57 offen offset:3072 lds
    s_mov_b32 m0, 81920
    s_add_u32 s57, s78, 4
    s_sub_u32 s77, s57, 14
    s_cmp_ge_u32 s57, 14
    s_cselect_b32 s57, s77, s57
    s_lshl_b32 s57, s57, 17
    s_add_u32 s57, s57, 65536
    buffer_load_dwordx4 v8, s[40:43], s57 offen offset:0 lds
    buffer_load_dwordx4 v9, s[40:43], s57 offen offset:1024 lds
    buffer_load_dwordx4 v10, s[40:43], s57 offen offset:2048 lds
    buffer_load_dwordx4 v11, s[40:43], s57 offen offset:3072 lds
    s_mov_b32 m0, 86016
    s_add_u32 s57, s78, 5
    s_sub_u32 s77, s57, 14
    s_cmp_ge_u32 s57, 14
    s_cselect_b32 s57, s77, s57
    s_lshl_b32 s57, s57, 17
    s_add_u32 s57, s57, 65536
    buffer_load_dwordx4 v8, s[40:43], s57 offen offset:0 lds
    buffer_load_dwordx4 v9, s[40:43], s57 offen offset:1024 lds
    buffer_load_dwordx4 v10, s[40:43], s57 offen offset:2048 lds
    buffer_load_dwordx4 v11, s[40:43], s57 offen offset:3072 lds
    s_mov_b32 m0, 90112
    s_add_u32 s57, s78, 6
    s_sub_u32 s77, s57, 14
    s_cmp_ge_u32 s57, 14
    s_cselect_b32 s57, s77, s57
    s_lshl_b32 s57, s57, 17
    s_add_u32 s57, s57, 65536
    buffer_load_dwordx4 v8, s[40:43], s57 offen offset:0 lds
    buffer_load_dwordx4 v9, s[40:43], s57 offen offset:1024 lds
    buffer_load_dwordx4 v10, s[40:43], s57 offen offset:2048 lds
    buffer_load_dwordx4 v11, s[40:43], s57 offen offset:3072 lds
    s_waitcnt vmcnt(28)
    ds_write_b32 v17, v16 offset:68
fr_12:
    ds_read_b128 v[20:23], v17 offset:32
    s_waitcnt lgkmcnt(0)
    v_min_u32 v20, v20, v21
    v_min3_u32 v20, v20, v22, v23
    v_cmp_le_u32 vcc, 8, v20
    s_cbranch_vccnz fr_12_d
    s_sleep 2
    s_add_u32 s72, s72, 1
    s_cmp_lt_u32 s72, 0x80000
    s_cbranch_scc1 fr_12
fr_12_d:
    s_mov_b32 m0, 98304
    s_add_u32 s57, s78, 0
    s_sub_u32 s77, s57, 14
    s_cmp_ge_u32 s57, 14
    s_cselect_b32 s57, s77, s57
    s_lshl_b32 s57, s57, 17
    s_add_u32 s57, s57, 98304
    buffer_load_dwordx4 v8, s[40:43], s57 offen offset:0 lds
    buffer_load_dwordx4 v9, s[40:43], s57 offen offset:1024 lds
    buffer_load_dwordx4 v10, s[40:43], s57 offen offset:2048 lds
    buffer_load_dwordx4 v11, s[40:43], s57 offen offset:3072 lds
    s_mov_b32 m0, 102400
    s_add_u32 s57, s78, 1
    s_sub_u32 s77, s57, 14
    s_cmp_ge_u32 s57, 14
    s_cselect_b32 s57, s77, s57
    s_lshl_b32 s57, s57, 17
    s_add_u32 s57, s57, 98304
    buffer_load_dwordx4 v8, s[40:43], s57 offen offset:0 lds
    buffer_load_dwordx4 v9, s[40:43], s57 offen offset:1024 lds
    buffer_load_dwordx4 v10, s[40:43], s57 offen offset:2048 lds
    buffer_load_dwordx4 v11, s[40:43], s57 offen offset:3072 lds
    s_mov_b32 m0, 106496
    s_add_u32 s57, s78, 2
    s_sub_u32 s77, s57, 14
    s_cmp_ge_u32 s57, 14
    s_cselect_b32 s57, s77, s57
    s_lshl_b32 s57, s57, 17
    s_add_u32 s57, s57, 98304
    buffer_load_dwordx4 v8, s[40:43], s57 offen offset:0 lds
    buffer_load_dwordx4 v9, s[40:43], s57 offen offset:1024 lds
    buffer_load_dwordx4 v10, s[40:43], s57 offen offset:2048 lds
    buffer_load_dwordx4 v11, s[40:43], s57 offen offset:3072 lds
    s_mov_b32 m0, 110592
    s_add_u32 s57, s78, 3
    s_sub_u32 s77, s57, 14
    s_cmp_ge_u32 s57, 14
    s_cselect_b32 s57, s77, s57
    s_lshl_b32 s57, s57, 17
    s_add_u32 s57, s57, 98304
    buffer_load_dwordx4 v8, s[40:43], s57 offen offset:0 lds
    buffer_load_dwordx4 v9, s[40:43], s57 offen offset:1024 lds
    buffer_load_dwordx4 v10, s[40:43], s57 offen offset:2048 lds
    buffer_load_dwordx4 v11, s[40:43], s57 offen offset:3072 lds
    s_mov_b32 m0, 114688
    s_add_u32 s57, s78, 4
    s_sub_u32 s77, s57, 14
    s_cmp_ge_u32 s57, 14
    s_cselect_b32 s57, s77, s57
    s_lshl_b32 s57, s57, 17
    s_add_u32 s57, s57, 98304
    buffer_load_dwordx4 v8, s[40:43], s57 offen offset:0 lds
    buffer_load_dwordx4 v9, s[40:43], s57 offen offset:1024 lds
    buffer_load_dwordx4 v10, s[40:43], s57 offen offset:2048 lds
    buffer_load_dwordx4 v11, s[40:43], s57 offen offset:3072 lds
    s_mov_b32 m0, 118784
    s_add_u32 s57, s78, 5
    s_sub_u32 s77, s57, 14
    s_cmp_ge_u32 s57, 14
    s_cselect_b32 s57, s77, s57
    s_lshl_b32 s57, s57, 17
    s_add_u32 s57, s57, 98304
    buffer_load_dwordx4 v8, s[40:43], s57 offen offset:0 lds
    buffer_load_dwordx4 v9, s[40:43], s57 offen offset:1024 lds
    buffer_load_dwordx4 v10, s[40:43], s57 offen offset:2048 lds
    buffer_load_dwordx4 v11, s[40:43], s57 offen offset:3072 lds
    s_mov_b32 m0, 122880
    s_add_u32 s57, s78, 6
    s_sub_u32 s77, s57, 14
    s_cmp_ge_u32 s57, 14
    s_cselect_b32 s57, s77, s57
    s_lshl_b32 s57, s57, 17
    s_add_u32 s57, s57, 98304
    buffer_load_dwordx4 v8, s[40:43], s57 offen offset:0 lds
    buffer_load_dwordx4 v9, s[40:43], s57 offen offset:1024 lds
    buffer_load_dwordx4 v10, s[40:43], s57 offen offset:2048 lds
    buffer_load_dwordx4 v11, s[40:43], s57 offen offset:3072 lds
    s_waitcnt vmcnt(28)
    ds_write_b32 v17, v16 offset:72
    s_waitcnt vmcnt(0)
    ds_write_b32 v17, v16 offset:76
    s_branch K_conv
K_gemm:
    s_setprio 2
    v_and_b32 v19, 15, v1
    v_lshrrev_b32 v3, 4, v1
    s_mov_b32 s40, s22
    s_mov_b32 s41, s23
    s_mov_b32 s42, 3584
    s_mov_b32 s43, 0x00020000
    s_add_u32 s44, s24, 8388608
    s_addc_u32 s45, s25, 0
    s_mov_b32 s46, 7340032
    s_mov_b32 s47, 0x00020000
    v_bfe_u32 v6, v1, 2, 2
    v_and_b32 v9, 1, v3
    v_lshl_or_b32 v9, v9, 2, v6
    v_lshl_add_u32 v10, v3, 3, v6
    v_lshlrev_b32 v10, 8, v10
    v_and_b32 v11, 3, v1
    v_lshl_add_u32 v10, v11, 3, v10
    s_and_b32 s68, s83, 1
    s_mul_i32 s53, s83, 224
    v_lshlrev_b32 v7, 3, v3
    s_lshl_b32 s59, s3, 1
    s_add_u32 s59, s59, 0
    s_sub_u32 s67, s59, 7
    s_cmp_ge_u32 s59, 7
    s_cselect_b32 s60, s67, s59
    s_add_u32 s59, s60, s68
    v_xor_b32 v11, s59, v9
    v_lshl_add_u32 v12, v11, 5, v10
    s_lshl_b32 s59, s60, 6
    s_add_u32 s59, s59, 157152
    v_lshl_add_u32 v226, v3, 4, s59
    s_lshl_b32 s59, s60, 5
    s_add_u32 s59, s59, 159648
    v_add_u32 v20, s59, v7
    s_lshl_b32 s59, s3, 1
    s_add_u32 s59, s59, 1
    s_sub_u32 s67, s59, 7
    s_cmp_ge_u32 s59, 7
    s_cselect_b32 s61, s67, s59
    s_add_u32 s59, s61, s68
    v_xor_b32 v11, s59, v9
    v_lshl_add_u32 v13, v11, 5, v10
    s_lshl_b32 s59, s61, 6
    s_add_u32 s59, s59, 157152
    v_lshl_add_u32 v227, v3, 4, s59
    s_lshl_b32 s59, s61, 5
    s_add_u32 s59, s59, 159648
    v_add_u32 v22, s59, v7
    s_lshl_b32 s59, s3, 1
    s_add_u32 s59, s59, 2
    s_sub_u32 s67, s59, 7
    s_cmp_ge_u32 s59, 7
    s_cselect_b32 s62, s67, s59
    s_add_u32 s59, s62, s68
    v_xor_b32 v11, s59, v9
    v_lshl_add_u32 v14, v11, 5, v10
    s_lshl_b32 s59, s62, 6
    s_add_u32 s59, s59, 157152
    v_lshl_add_u32 v228, v3, 4, s59
    s_lshl_b32 s59, s62, 5
    s_add_u32 s59, s59, 159648
    v_add_u32 v24, s59, v7
    s_lshl_b32 s59, s3, 1
    s_add_u32 s59, s59, 3
    s_sub_u32 s67, s59, 7
    s_cmp_ge_u32 s59, 7
    s_cselect_b32 s63, s67, s59
    s_add_u32 s59, s63, s68
    v_xor_b32 v11, s59, v9
    v_lshl_add_u32 v15, v11, 5, v10
    s_lshl_b32 s59, s63, 6
    s_add_u32 s59, s59, 157152
    v_lshl_add_u32 v229, v3, 4, s59
    s_lshl_b32 s59, s63, 5
    s_add_u32 s59, s59, 159648
    v_add_u32 v26, s59, v7
    s_lshl_b32 s59, s3, 1
    s_add_u32 s59, s59, 4
    s_sub_u32 s67, s59, 7
    s_cmp_ge_u32 s59, 7
    s_cselect_b32 s64, s67, s59
    s_add_u32 s59, s64, s68
    v_xor_b32 v11, s59, v9
    v_lshl_add_u32 v16, v11, 5, v10
    s_lshl_b32 s59, s64, 6
    s_add_u32 s59, s59, 157152
    v_lshl_add_u32 v230, v3, 4, s59
    s_lshl_b32 s59, s64, 5
    s_add_u32 s59, s59, 159648
    v_add_u32 v28, s59, v7
    s_lshl_b32 s59, s3, 1
    s_add_u32 s59, s59, 5
    s_sub_u32 s67, s59, 7
    s_cmp_ge_u32 s59, 7
    s_cselect_b32 s65, s67, s59
    s_add_u32 s59, s65, s68
    v_xor_b32 v11, s59, v9
    v_lshl_add_u32 v17, v11, 5, v10
    s_lshl_b32 s59, s65, 6
    s_add_u32 s59, s59, 157152
    v_lshl_add_u32 v231, v3, 4, s59
    s_lshl_b32 s59, s65, 5
    s_add_u32 s59, s59, 159648
    v_add_u32 v30, s59, v7
    s_lshl_b32 s59, s3, 1
    s_add_u32 s59, s59, 6
    s_sub_u32 s67, s59, 7
    s_cmp_ge_u32 s59, 7
    s_cselect_b32 s66, s67, s59
    s_add_u32 s59, s66, s68
    v_xor_b32 v11, s59, v9
    v_lshl_add_u32 v18, v11, 5, v10
    s_lshl_b32 s59, s66, 6
    s_add_u32 s59, s59, 157152
    v_lshl_add_u32 v232, v3, 4, s59
    s_lshl_b32 s59, s66, 5
    s_add_u32 s59, s59, 159648
    v_add_u32 v32, s59, v7
    v_lshrrev_b32 v6, 1, v19
    v_xor_b32 v6, v6, v3
    v_lshlrev_b32 v6, 4, v6
    v_lshl_add_u32 v6, v19, 7, v6
    s_lshl_b32 s59, s3, 12
    s_add_u32 s59, s59, 16384
    v_add_u32 v4, s59, v6
    v_xor_b32 v5, 64, v4
    v_mov_b32 v36, 0x3f803f80
    v_mov_b32 v37, 0x3f803f80
    v_mov_b32 v38, 0x3f803f80
    v_mov_b32 v39, 0x3f803f80
    v_mov_b32 v34, 1
    s_lshl_b32 s59, s3, 2
    s_add_u32 s59, s59, 156864
    v_mov_b32 v35, s59
    v_mov_b32 v2, 156864
    v_mov_b32 v220, 0xbdd2d3e8
    v_mov_b32 v222, 0xc0135761
    v_mov_b32 v224, 1.0
    s_lshl_b32 s59, s3, 8
    s_add_u32 s59, s59, 158624
    v_lshl_add_u32 v160, v19, 3, s59
    s_lshl_b32 s52, s82, 3
    s_lshl_b32 s53, s3, 1
    s_add_u32 s52, s52, s53
    s_mul_i32 s52, s52, 57344
    s_mul_i32 s53, s83, 3584
    s_add_u32 s52, s52, s53
    v_lshrrev_b32 v8, 1, v3
    v_lshlrev_b32 v8, 8, v8
    v_lshl_add_u32 v8, v19, 4, v8
    v_add_u32 v8, s52, v8
    v_and_b32 v10, 1, v3
    v_cmp_eq_u32 vcc, 1, v10
    s_lshl_b32 s59, s60, 9
    s_lshl_b32 s67, s61, 9
    v_mov_b32 v10, s59
    v_mov_b32 v11, s67
    v_cndmask_b32 v10, v10, v11, vcc
    v_add_u32 v216, v10, v8
    s_lshl_b32 s59, s62, 9
    s_lshl_b32 s67, s63, 9
    v_mov_b32 v10, s59
    v_mov_b32 v11, s67
    v_cndmask_b32 v10, v10, v11, vcc
    v_add_u32 v217, v10, v8
    s_lshl_b32 s59, s64, 9
    s_lshl_b32 s67, s65, 9
    v_mov_b32 v10, s59
    v_mov_b32 v11, s67
    v_cndmask_b32 v10, v10, v11, vcc
    v_add_u32 v218, v10, v8
    s_lshl_b32 s59, s66, 9
    s_add_u32 s67, s59, 57344
    v_mov_b32 v10, s59
    v_mov_b32 v11, s67
    v_cndmask_b32 v10, v10, v11, vcc
    v_add_u32 v219, v10, v8
    s_mov_b32 s59, 57344
    v_mov_b32 v206, 1
    v_mov_b32 v207, 2
    v_mov_b32 v208, 3
    v_mov_b32 v209, 4
    v_mov_b32 v210, 5
    v_mov_b32 v211, 6
    v_mov_b32 v212, 7
    v_mov_b32 v213, 8
    v_mov_b32 v214, 9
sp_13:
    ds_read2_b32 v[40:41], v2 offset0:0 offset1:52
    s_waitcnt lgkmcnt(0)
    v_min_u32 v40, v40, v41
    v_cmp_eq_u32 vcc, 1, v40
    s_cbranch_vccnz sp_13_d
    s_sleep 1
    s_add_u32 s72, s72, 1
    s_cmp_lt_u32 s72, 0x80000
    s_cbranch_scc1 sp_13
sp_13_d:
    ds_read_b128 v[128:131], v4 offset:0
    ds_read_b128 v[132:135], v4 offset:2048
    ds_read_b64_tr_b16 v[44:45], v12 offset:0
    ds_read_b64_tr_b16 v[46:47], v12 offset:1024
    ds_read_b64_tr_b16 v[48:49], v13 offset:0
    ds_read_b64_tr_b16 v[50:51], v13 offset:1024
    ds_read_b64_tr_b16 v[52:53], v14 offset:0
    ds_read_b64_tr_b16 v[54:55], v14 offset:1024
    ds_read_b64_tr_b16 v[56:57], v15 offset:0
    ds_read_b64_tr_b16 v[58:59], v15 offset:1024
    ds_read_b64_tr_b16 v[60:61], v16 offset:0
    ds_read_b64_tr_b16 v[62:63], v16 offset:1024
    ds_read_b64_tr_b16 v[64:65], v17 offset:0
    ds_read_b64_tr_b16 v[66:67], v17 offset:1024
    ds_read_b64_tr_b16 v[68:69], v18 offset:0
    ds_read_b64_tr_b16 v[70:71], v18 offset:1024
    s_waitcnt lgkmcnt(10)
    v_mfma_f32_16x16x32_bf16 v[72:75], v[44:47], v[128:131], 0
    v_mfma_f32_16x16x32_bf16 v[76:79], v[44:47], v[132:135], 0
    v_mfma_f32_16x16x32_bf16 v[192:195], v[44:47], v[36:39], 0
    ds_read_b128 v[136:139], v5 offset:0
    v_mfma_f32_16x16x32_bf16 v[80:83], v[48:51], v[128:131], 0
    ds_read_b64_tr_b16 v[44:45], v12 offset:8192
    v_mfma_f32_16x16x32_bf16 v[84:87], v[48:51], v[132:135], 0
    ds_read_b64_tr_b16 v[46:47], v12 offset:9216
    v_mfma_f32_16x16x32_bf16 v[196:199], v[48:51], v[36:39], 0
    ds_read_b128 v[140:143], v5 offset:2048
    s_waitcnt lgkmcnt(10)
    v_mfma_f32_16x16x32_bf16 v[88:91], v[52:55], v[128:131], 0
    ds_read_b64_tr_b16 v[48:49], v13 offset:8192
    v_mfma_f32_16x16x32_bf16 v[92:95], v[52:55], v[132:135], 0
    ds_read_b64_tr_b16 v[50:51], v13 offset:9216
    v_mfma_f32_16x16x32_bf16 v[96:99], v[56:59], v[128:131], 0
    ds_read_b64_tr_b16 v[52:53], v14 offset:8192
    v_mfma_f32_16x16x32_bf16 v[100:103], v[56:59], v[132:135], 0
    ds_read_b64_tr_b16 v[54:55], v14 offset:9216
    s_waitcnt lgkmcnt(10)
    v_mfma_f32_16x16x32_bf16 v[104:107], v[60:63], v[128:131], 0
    ds_read_b64_tr_b16 v[56:57], v15 offset:8192
    v_mfma_f32_16x16x32_bf16 v[108:111], v[60:63], v[132:135], 0
    ds_read_b64_tr_b16 v[58:59], v15 offset:9216
    v_mfma_f32_16x16x32_bf16 v[112:115], v[64:67], v[128:131], 0
    ds_read_b64_tr_b16 v[60:61], v16 offset:8192
    ds_read2_b32 v[40:41], v2 offset0:1 offset1:53
    v_mfma_f32_16x16x32_bf16 v[116:119], v[64:67], v[132:135], 0
    ds_read_b64_tr_b16 v[62:63], v16 offset:9216
    s_waitcnt lgkmcnt(13)
    v_mfma_f32_16x16x32_bf16 v[120:123], v[68:71], v[128:131], 0
    ds_read_b64_tr_b16 v[64:65], v17 offset:8192
    v_mfma_f32_16x16x32_bf16 v[124:127], v[68:71], v[132:135], 0
    ds_read_b64_tr_b16 v[66:67], v17 offset:9216
    s_waitcnt lgkmcnt(9)
    v_mfma_f32_16x16x32_bf16 v[72:75], v[44:47], v[136:139], v[72:75]
    ds_read_b64_tr_b16 v[68:69], v18 offset:8192
    s_waitcnt lgkmcnt(4)
    v_and_b32 v40, v40, v41
    v_cmp_eq_u32 vcc, 1, v40
    s_cbranch_vccnz fu_15
fu_14:
    ds_read2_b32 v[40:41], v2 offset0:1 offset1:53
    s_waitcnt lgkmcnt(0)
    v_and_b32 v40, v40, v41
    v_cmp_eq_u32 vcc, 1, v40
    s_cbranch_vccnz fu_15
    s_add_u32 s72, s72, 1
    s_cmp_lt_u32 s72, 0x80000
    s_cbranch_scc1 fu_14
fu_15:
    v_mfma_f32_16x16x32_bf16 v[76:79], v[44:47], v[140:143], v[76:79]
    ds_read_b64_tr_b16 v[70:71], v18 offset:9216
    v_mfma_f32_16x16x32_bf16 v[192:195], v[44:47], v[36:39], v[192:195]
    ds_read_b128 v[128:131], v4 offset:32768
    v_mfma_f32_16x16x32_bf16 v[80:83], v[48:51], v[136:139], v[80:83]
    ds_read_b64_tr_b16 v[44:45], v12 offset:32768
    v_mfma_f32_16x16x32_bf16 v[84:87], v[48:51], v[140:143], v[84:87]
    ds_read_b64_tr_b16 v[46:47], v12 offset:33792
    v_mfma_f32_16x16x32_bf16 v[196:199], v[48:51], v[36:39], v[196:199]
    ds_read_b128 v[132:135], v4 offset:34816
    v_mfma_f32_16x16x32_bf16 v[88:91], v[52:55], v[136:139], v[88:91]
    ds_read_b64_tr_b16 v[48:49], v13 offset:32768
    v_mfma_f32_16x16x32_bf16 v[92:95], v[52:55], v[140:143], v[92:95]
    ds_read_b64_tr_b16 v[50:51], v13 offset:33792
    v_mfma_f32_16x16x32_bf16 v[96:99], v[56:59], v[136:139], v[96:99]
    ds_read_b64_tr_b16 v[52:53], v14 offset:32768
    v_mfma_f32_16x16x32_bf16 v[100:103], v[56:59], v[140:143], v[100:103]
    ds_read_b64_tr_b16 v[54:55], v14 offset:33792
    s_waitcnt lgkmcnt(10)
    v_mfma_f32_16x16x32_bf16 v[104:107], v[60:63], v[136:139], v[104:107]
    ds_read_b64_tr_b16 v[56:57], v15 offset:32768
    v_mfma_f32_16x16x32_bf16 v[108:111], v[60:63], v[140:143], v[108:111]
    ds_read_b64_tr_b16 v[58:59], v15 offset:33792
    v_mfma_f32_16x16x32_bf16 v[112:115], v[64:67], v[136:139], v[112:115]
    ds_read_b64_tr_b16 v[60:61], v16 offset:32768
    v_mfma_f32_16x16x32_bf16 v[116:119], v[64:67], v[140:143], v[116:119]
    ds_read_b64_tr_b16 v[62:63], v16 offset:33792
    s_waitcnt lgkmcnt(12)
    v_mfma_f32_16x16x32_bf16 v[120:123], v[68:71], v[136:139], v[120:123]
    ds_read_b64_tr_b16 v[64:65], v17 offset:32768
    ds_write_b32 v35, v206 offset:32
    v_mfma_f32_16x16x32_bf16 v[124:127], v[68:71], v[140:143], v[124:127]
    ds_read_b64_tr_b16 v[66:67], v17 offset:33792
    s_waitcnt lgkmcnt(9)
    v_mfma_f32_16x16x32_bf16 v[72:75], v[44:47], v[128:131], v[72:75]
    ds_read_b64_tr_b16 v[68:69], v18 offset:32768
    v_mfma_f32_16x16x32_bf16 v[76:79], v[44:47], v[132:135], v[76:79]
    ds_read_b64_tr_b16 v[70:71], v18 offset:33792
    v_mfma_f32_16x16x32_bf16 v[192:195], v[44:47], v[36:39], v[192:195]
    ds_read_b128 v[136:139], v5 offset:32768
    v_mfma_f32_16x16x32_bf16 v[80:83], v[48:51], v[128:131], v[80:83]
    ds_read_b64_tr_b16 v[44:45], v12 offset:40960
    v_mfma_f32_16x16x32_bf16 v[84:87], v[48:51], v[132:135], v[84:87]
    ds_read_b64_tr_b16 v[46:47], v12 offset:41984
    v_mfma_f32_16x16x32_bf16 v[196:199], v[48:51], v[36:39], v[196:199]
    ds_read_b128 v[140:143], v5 offset:34816
    s_waitcnt lgkmcnt(11)
    v_mfma_f32_16x16x32_bf16 v[88:91], v[52:55], v[128:131], v[88:91]
    ds_read_b64_tr_b16 v[48:49], v13 offset:40960
    v_mfma_f32_16x16x32_bf16 v[92:95], v[52:55], v[132:135], v[92:95]
    ds_read_b64_tr_b16 v[50:51], v13 offset:41984
    v_mfma_f32_16x16x32_bf16 v[96:99], v[56:59], v[128:131], v[96:99]
    ds_read_b64_tr_b16 v[52:53], v14 offset:40960
    v_mfma_f32_16x16x32_bf16 v[100:103], v[56:59], v[132:135], v[100:103]
    ds_read_b64_tr_b16 v[54:55], v14 offset:41984
    s_waitcnt lgkmcnt(10)
    v_mfma_f32_16x16x32_bf16 v[104:107], v[60:63], v[128:131], v[104:107]
    ds_read_b64_tr_b16 v[56:57], v15 offset:40960
    v_mfma_f32_16x16x32_bf16 v[108:111], v[60:63], v[132:135], v[108:111]
    ds_read_b64_tr_b16 v[58:59], v15 offset:41984
    v_mfma_f32_16x16x32_bf16 v[112:115], v[64:67], v[128:131], v[112:115]
    ds_read_b64_tr_b16 v[60:61], v16 offset:40960
    ds_read2_b32 v[40:41], v2 offset0:2 offset1:54
    v_mfma_f32_16x16x32_bf16 v[116:119], v[64:67], v[132:135], v[116:119]
    ds_read_b64_tr_b16 v[62:63], v16 offset:41984
    s_waitcnt lgkmcnt(13)
    v_mfma_f32_16x16x32_bf16 v[120:123], v[68:71], v[128:131], v[120:123]
    ds_read_b64_tr_b16 v[64:65], v17 offset:40960
    v_mfma_f32_16x16x32_bf16 v[124:127], v[68:71], v[132:135], v[124:127]
    ds_read_b64_tr_b16 v[66:67], v17 offset:41984
    s_waitcnt lgkmcnt(9)
    v_mfma_f32_16x16x32_bf16 v[72:75], v[44:47], v[136:139], v[72:75]
    ds_read_b64_tr_b16 v[68:69], v18 offset:40960
    s_waitcnt lgkmcnt(4)
    v_and_b32 v40, v40, v41
    v_cmp_eq_u32 vcc, 1, v40
    s_cbranch_vccnz fu_17
fu_16:
    ds_read2_b32 v[40:41], v2 offset0:2 offset1:54
    s_waitcnt lgkmcnt(0)
    v_and_b32 v40, v40, v41
    v_cmp_eq_u32 vcc, 1, v40
    s_cbranch_vccnz fu_17
    s_add_u32 s72, s72, 1
    s_cmp_lt_u32 s72, 0x80000
    s_cbranch_scc1 fu_16
fu_17:
    v_xor_b32 v4, 0x10000, v4
    v_xor_b32 v5, 0x10000, v5
    v_xor_b32 v12, 0x10000, v12
    v_mfma_f32_16x16x32_bf16 v[76:79], v[44:47], v[140:143], v[76:79]
    ds_read_b64_tr_b16 v[70:71], v18 offset:41984
    v_mfma_f32_16x16x32_bf16 v[192:195], v[44:47], v[36:39], v[192:195]
    ds_read_b128 v[128:131], v4 offset:0
    v_mfma_f32_16x16x32_bf16 v[80:83], v[48:51], v[136:139], v[80:83]
    ds_read_b64_tr_b16 v[44:45], v12 offset:0
    v_xor_b32 v13, 0x10000, v13
    v_mfma_f32_16x16x32_bf16 v[84:87], v[48:51], v[140:143], v[84:87]
    ds_read_b64_tr_b16 v[46:47], v12 offset:1024
    v_mfma_f32_16x16x32_bf16 v[196:199], v[48:51], v[36:39], v[196:199]
    ds_read_b128 v[132:135], v4 offset:2048
    v_mfma_f32_16x16x32_bf16 v[88:91], v[52:55], v[136:139], v[88:91]
    ds_read_b64_tr_b16 v[48:49], v13 offset:0
    v_xor_b32 v14, 0x10000, v14
    v_mfma_f32_16x16x32_bf16 v[92:95], v[52:55], v[140:143], v[92:95]
    ds_read_b64_tr_b16 v[50:51], v13 offset:1024
    v_mfma_f32_16x16x32_bf16 v[96:99], v[56:59], v[136:139], v[96:99]
    ds_read_b64_tr_b16 v[52:53], v14 offset:0
    v_xor_b32 v15, 0x10000, v15
    v_mfma_f32_16x16x32_bf16 v[100:103], v[56:59], v[140:143], v[100:103]
    ds_read_b64_tr_b16 v[54:55], v14 offset:1024
    s_waitcnt lgkmcnt(10)
    v_mfma_f32_16x16x32_bf16 v[104:107], v[60:63], v[136:139], v[104:107]
    ds_read_b64_tr_b16 v[56:57], v15 offset:0
    v_xor_b32 v16, 0x10000, v16
    v_mfma_f32_16x16x32_bf16 v[108:111], v[60:63], v[140:143], v[108:111]
    ds_read_b64_tr_b16 v[58:59], v15 offset:1024
    v_mfma_f32_16x16x32_bf16 v[112:115], v[64:67], v[136:139], v[112:115]
    ds_read_b64_tr_b16 v[60:61], v16 offset:0
    v_xor_b32 v17, 0x10000, v17
    v_mfma_f32_16x16x32_bf16 v[116:119], v[64:67], v[140:143], v[116:119]
    ds_read_b64_tr_b16 v[62:63], v16 offset:1024
    s_waitcnt lgkmcnt(12)
    v_mfma_f32_16x16x32_bf16 v[120:123], v[68:71], v[136:139], v[120:123]
    ds_read_b64_tr_b16 v[64:65], v17 offset:0
    v_xor_b32 v18, 0x10000, v18
    ds_write_b32 v35, v207 offset:32
    v_mfma_f32_16x16x32_bf16 v[124:127], v[68:71], v[140:143], v[124:127]
    ds_read_b64_tr_b16 v[66:67], v17 offset:1024
    s_waitcnt lgkmcnt(9)
    v_mfma_f32_16x16x32_bf16 v[72:75], v[44:47], v[128:131], v[72:75]
    ds_read_b64_tr_b16 v[68:69], v18 offset:0
    v_mfma_f32_16x16x32_bf16 v[76:79], v[44:47], v[132:135], v[76:79]
    ds_read_b64_tr_b16 v[70:71], v18 offset:1024
    v_mfma_f32_16x16x32_bf16 v[192:195], v[44:47], v[36:39], v[192:195]
    ds_read_b128 v[136:139], v5 offset:0
    v_mfma_f32_16x16x32_bf16 v[80:83], v[48:51], v[128:131], v[80:83]
    ds_read_b64_tr_b16 v[44:45], v12 offset:8192
    v_mfma_f32_16x16x32_bf16 v[84:87], v[48:51], v[132:135], v[84:87]
    ds_read_b64_tr_b16 v[46:47], v12 offset:9216
    v_mfma_f32_16x16x32_bf16 v[196:199], v[48:51], v[36:39], v[196:199]
    ds_read_b128 v[140:143], v5 offset:2048
    s_waitcnt lgkmcnt(11)
    v_mfma_f32_16x16x32_bf16 v[88:91], v[52:55], v[128:131], v[88:91]
    ds_read_b64_tr_b16 v[48:49], v13 offset:8192
    v_mfma_f32_16x16x32_bf16 v[92:95], v[52:55], v[132:135], v[92:95]
    ds_read_b64_tr_b16 v[50:51], v13 offset:9216
    v_mfma_f32_16x16x32_bf16 v[96:99], v[56:59], v[128:131], v[96:99]
    ds_read_b64_tr_b16 v[52:53], v14 offset:8192
    v_mfma_f32_16x16x32_bf16 v[100:103], v[56:59], v[132:135], v[100:103]
    ds_read_b64_tr_b16 v[54:55], v14 offset:9216
    s_waitcnt lgkmcnt(10)
    v_mfma_f32_16x16x32_bf16 v[104:107], v[60:63], v[128:131], v[104:107]
    ds_read_b64_tr_b16 v[56:57], v15 offset:8192
    v_mfma_f32_16x16x32_bf16 v[108:111], v[60:63], v[132:135], v[108:111]
    ds_read_b64_tr_b16 v[58:59], v15 offset:9216
    v_mfma_f32_16x16x32_bf16 v[112:115], v[64:67], v[128:131], v[112:115]
    ds_read_b64_tr_b16 v[60:61], v16 offset:8192
    ds_read2_b32 v[40:41], v2 offset0:3 offset1:55
    v_mfma_f32_16x16x32_bf16 v[116:119], v[64:67], v[132:135], v[116:119]
    ds_read_b64_tr_b16 v[62:63], v16 offset:9216
    s_waitcnt lgkmcnt(13)
    v_mfma_f32_16x16x32_bf16 v[120:123], v[68:71], v[128:131], v[120:123]
    ds_read_b64_tr_b16 v[64:65], v17 offset:8192
    v_mfma_f32_16x16x32_bf16 v[124:127], v[68:71], v[132:135], v[124:127]
    ds_read_b64_tr_b16 v[66:67], v17 offset:9216
    s_waitcnt lgkmcnt(9)
    v_mfma_f32_16x16x32_bf16 v[72:75], v[44:47], v[136:139], v[72:75]
    ds_read_b64_tr_b16 v[68:69], v18 offset:8192
    s_waitcnt lgkmcnt(4)
    v_and_b32 v40, v40, v41
    v_cmp_eq_u32 vcc, 1, v40
    s_cbranch_vccnz fu_19
fu_18:
    ds_read2_b32 v[40:41], v2 offset0:3 offset1:55
    s_waitcnt lgkmcnt(0)
    v_and_b32 v40, v40, v41
    v_cmp_eq_u32 vcc, 1, v40
    s_cbranch_vccnz fu_19
    s_add_u32 s72, s72, 1
    s_cmp_lt_u32 s72, 0x80000
    s_cbranch_scc1 fu_18
fu_19:
    v_mfma_f32_16x16x32_bf16 v[76:79], v[44:47], v[140:143], v[76:79]
    ds_read_b64_tr_b16 v[70:71], v18 offset:9216
    v_mfma_f32_16x16x32_bf16 v[192:195], v[44:47], v[36:39], v[192:195]
    ds_read_b128 v[128:131], v4 offset:32768
    v_mfma_f32_16x16x32_bf16 v[80:83], v[48:51], v[136:139], v[80:83]
    ds_read_b64_tr_b16 v[44:45], v12 offset:32768
    v_mfma_f32_16x16x32_bf16 v[84:87], v[48:51], v[140:143], v[84:87]
    ds_read_b64_tr_b16 v[46:47], v12 offset:33792
    v_mfma_f32_16x16x32_bf16 v[196:199], v[48:51], v[36:39], v[196:199]
    ds_read_b128 v[132:135], v4 offset:34816
    v_mfma_f32_16x16x32_bf16 v[88:91], v[52:55], v[136:139], v[88:91]
    ds_read_b64_tr_b16 v[48:49], v13 offset:32768
    v_mfma_f32_16x16x32_bf16 v[92:95], v[52:55], v[140:143], v[92:95]
    ds_read_b64_tr_b16 v[50:51], v13 offset:33792
    v_mfma_f32_16x16x32_bf16 v[96:99], v[56:59], v[136:139], v[96:99]
    ds_read_b64_tr_b16 v[52:53], v14 offset:32768
    v_mfma_f32_16x16x32_bf16 v[100:103], v[56:59], v[140:143], v[100:103]
    ds_read_b64_tr_b16 v[54:55], v14 offset:33792
    s_waitcnt lgkmcnt(10)
    v_mfma_f32_16x16x32_bf16 v[104:107], v[60:63], v[136:139], v[104:107]
    ds_read_b64_tr_b16 v[56:57], v15 offset:32768
    v_mfma_f32_16x16x32_bf16 v[108:111], v[60:63], v[140:143], v[108:111]
    ds_read_b64_tr_b16 v[58:59], v15 offset:33792
    v_mfma_f32_16x16x32_bf16 v[112:115], v[64:67], v[136:139], v[112:115]
    ds_read_b64_tr_b16 v[60:61], v16 offset:32768
    v_mfma_f32_16x16x32_bf16 v[116:119], v[64:67], v[140:143], v[116:119]
    ds_read_b64_tr_b16 v[62:63], v16 offset:33792
    s_waitcnt lgkmcnt(12)
    v_mfma_f32_16x16x32_bf16 v[120:123], v[68:71], v[136:139], v[120:123]
    ds_read_b64_tr_b16 v[64:65], v17 offset:32768
    ds_write_b32 v35, v208 offset:32
    v_mfma_f32_16x16x32_bf16 v[124:127], v[68:71], v[140:143], v[124:127]
    ds_read_b64_tr_b16 v[66:67], v17 offset:33792
    s_waitcnt lgkmcnt(9)
    v_mfma_f32_16x16x32_bf16 v[72:75], v[44:47], v[128:131], v[72:75]
    ds_read_b64_tr_b16 v[68:69], v18 offset:32768
    v_mfma_f32_16x16x32_bf16 v[76:79], v[44:47], v[132:135], v[76:79]
    ds_read_b64_tr_b16 v[70:71], v18 offset:33792
    v_mfma_f32_16x16x32_bf16 v[192:195], v[44:47], v[36:39], v[192:195]
    ds_read_b128 v[136:139], v5 offset:32768
    v_mfma_f32_16x16x32_bf16 v[80:83], v[48:51], v[128:131], v[80:83]
    ds_read_b64_tr_b16 v[44:45], v12 offset:40960
    v_mfma_f32_16x16x32_bf16 v[84:87], v[48:51], v[132:135], v[84:87]
    ds_read_b64_tr_b16 v[46:47], v12 offset:41984
    v_mfma_f32_16x16x32_bf16 v[196:199], v[48:51], v[36:39], v[196:199]
    ds_read_b128 v[140:143], v5 offset:34816
    s_waitcnt lgkmcnt(11)
    v_mfma_f32_16x16x32_bf16 v[88:91], v[52:55], v[128:131], v[88:91]
    ds_read_b64_tr_b16 v[48:49], v13 offset:40960
    v_mfma_f32_16x16x32_bf16 v[92:95], v[52:55], v[132:135], v[92:95]
    ds_read_b64_tr_b16 v[50:51], v13 offset:41984
    v_mfma_f32_16x16x32_bf16 v[96:99], v[56:59], v[128:131], v[96:99]
    ds_read_b64_tr_b16 v[52:53], v14 offset:40960
    v_mfma_f32_16x16x32_bf16 v[100:103], v[56:59], v[132:135], v[100:103]
    ds_read_b64_tr_b16 v[54:55], v14 offset:41984
    s_waitcnt lgkmcnt(10)
    v_mfma_f32_16x16x32_bf16 v[104:107], v[60:63], v[128:131], v[104:107]
    ds_read_b64_tr_b16 v[56:57], v15 offset:40960
    v_mfma_f32_16x16x32_bf16 v[108:111], v[60:63], v[132:135], v[108:111]
    ds_read_b64_tr_b16 v[58:59], v15 offset:41984
    v_mfma_f32_16x16x32_bf16 v[112:115], v[64:67], v[128:131], v[112:115]
    ds_read_b64_tr_b16 v[60:61], v16 offset:40960
    ds_read2_b32 v[40:41], v2 offset0:4 offset1:56
    v_mfma_f32_16x16x32_bf16 v[116:119], v[64:67], v[132:135], v[116:119]
    ds_read_b64_tr_b16 v[62:63], v16 offset:41984
    s_waitcnt lgkmcnt(13)
    v_mfma_f32_16x16x32_bf16 v[120:123], v[68:71], v[128:131], v[120:123]
    ds_read_b64_tr_b16 v[64:65], v17 offset:40960
    v_mfma_f32_16x16x32_bf16 v[124:127], v[68:71], v[132:135], v[124:127]
    ds_read_b64_tr_b16 v[66:67], v17 offset:41984
    s_waitcnt lgkmcnt(9)
    v_mfma_f32_16x16x32_bf16 v[72:75], v[44:47], v[136:139], v[72:75]
    ds_read_b64_tr_b16 v[68:69], v18 offset:40960
    s_waitcnt lgkmcnt(4)
    v_and_b32 v40, v40, v41
    v_cmp_eq_u32 vcc, 1, v40
    s_cbranch_vccnz fu_21
fu_20:
    ds_read2_b32 v[40:41], v2 offset0:4 offset1:56
    s_waitcnt lgkmcnt(0)
    v_and_b32 v40, v40, v41
    v_cmp_eq_u32 vcc, 1, v40
    s_cbranch_vccnz fu_21
    s_add_u32 s72, s72, 1
    s_cmp_lt_u32 s72, 0x80000
    s_cbranch_scc1 fu_20
fu_21:
    v_xor_b32 v4, 0x10000, v4
    v_xor_b32 v5, 0x10000, v5
    v_xor_b32 v12, 0x10000, v12
    v_mfma_f32_16x16x32_bf16 v[76:79], v[44:47], v[140:143], v[76:79]
    ds_read_b64_tr_b16 v[70:71], v18 offset:41984
    v_mfma_f32_16x16x32_bf16 v[192:195], v[44:47], v[36:39], v[192:195]
    ds_read_b128 v[128:131], v4 offset:0
    v_mfma_f32_16x16x32_bf16 v[80:83], v[48:51], v[136:139], v[80:83]
    ds_read_b64_tr_b16 v[44:45], v12 offset:0
    v_xor_b32 v13, 0x10000, v13
    v_mfma_f32_16x16x32_bf16 v[84:87], v[48:51], v[140:143], v[84:87]
    ds_read_b64_tr_b16 v[46:47], v12 offset:1024
    v_mfma_f32_16x16x32_bf16 v[196:199], v[48:51], v[36:39], v[196:199]
    ds_read_b128 v[132:135], v4 offset:2048
    v_mfma_f32_16x16x32_bf16 v[88:91], v[52:55], v[136:139], v[88:91]
    ds_read_b64_tr_b16 v[48:49], v13 offset:0
    v_xor_b32 v14, 0x10000, v14
    v_mfma_f32_16x16x32_bf16 v[92:95], v[52:55], v[140:143], v[92:95]
    ds_read_b64_tr_b16 v[50:51], v13 offset:1024
    v_mfma_f32_16x16x32_bf16 v[96:99], v[56:59], v[136:139], v[96:99]
    ds_read_b64_tr_b16 v[52:53], v14 offset:0
    v_xor_b32 v15, 0x10000, v15
    v_mfma_f32_16x16x32_bf16 v[100:103], v[56:59], v[140:143], v[100:103]
    ds_read_b64_tr_b16 v[54:55], v14 offset:1024
    s_waitcnt lgkmcnt(10)
    v_mfma_f32_16x16x32_bf16 v[104:107], v[60:63], v[136:139], v[104:107]
    ds_read_b64_tr_b16 v[56:57], v15 offset:0
    v_xor_b32 v16, 0x10000, v16
    v_mfma_f32_16x16x32_bf16 v[108:111], v[60:63], v[140:143], v[108:111]
    ds_read_b64_tr_b16 v[58:59], v15 offset:1024
    v_mfma_f32_16x16x32_bf16 v[112:115], v[64:67], v[136:139], v[112:115]
    ds_read_b64_tr_b16 v[60:61], v16 offset:0
    v_xor_b32 v17, 0x10000, v17
    v_mfma_f32_16x16x32_bf16 v[116:119], v[64:67], v[140:143], v[116:119]
    ds_read_b64_tr_b16 v[62:63], v16 offset:1024
    s_waitcnt lgkmcnt(12)
    v_mfma_f32_16x16x32_bf16 v[120:123], v[68:71], v[136:139], v[120:123]
    ds_read_b64_tr_b16 v[64:65], v17 offset:0
    v_xor_b32 v18, 0x10000, v18
    ds_write_b32 v35, v209 offset:32
    v_mfma_f32_16x16x32_bf16 v[124:127], v[68:71], v[140:143], v[124:127]
    ds_read_b64_tr_b16 v[66:67], v17 offset:1024
    s_waitcnt lgkmcnt(9)
    v_mfma_f32_16x16x32_bf16 v[72:75], v[44:47], v[128:131], v[72:75]
    ds_read_b64_tr_b16 v[68:69], v18 offset:0
    v_mfma_f32_16x16x32_bf16 v[76:79], v[44:47], v[132:135], v[76:79]
    ds_read_b64_tr_b16 v[70:71], v18 offset:1024
    v_mfma_f32_16x16x32_bf16 v[192:195], v[44:47], v[36:39], v[192:195]
    ds_read_b128 v[136:139], v5 offset:0
    v_mfma_f32_16x16x32_bf16 v[80:83], v[48:51], v[128:131], v[80:83]
    ds_read_b64_tr_b16 v[44:45], v12 offset:8192
    v_mfma_f32_16x16x32_bf16 v[84:87], v[48:51], v[132:135], v[84:87]
    ds_read_b64_tr_b16 v[46:47], v12 offset:9216
    v_mfma_f32_16x16x32_bf16 v[196:199], v[48:51], v[36:39], v[196:199]
    ds_read_b128 v[140:143], v5 offset:2048
    s_waitcnt lgkmcnt(11)
    v_mfma_f32_16x16x32_bf16 v[88:91], v[52:55], v[128:131], v[88:91]
    ds_read_b64_tr_b16 v[48:49], v13 offset:8192
    v_mfma_f32_16x16x32_bf16 v[92:95], v[52:55], v[132:135], v[92:95]
    ds_read_b64_tr_b16 v[50:51], v13 offset:9216
    v_mfma_f32_16x16x32_bf16 v[96:99], v[56:59], v[128:131], v[96:99]
    ds_read_b64_tr_b16 v[52:53], v14 offset:8192
    v_mfma_f32_16x16x32_bf16 v[100:103], v[56:59], v[132:135], v[100:103]
    ds_read_b64_tr_b16 v[54:55], v14 offset:9216
    s_waitcnt lgkmcnt(10)
    v_mfma_f32_16x16x32_bf16 v[104:107], v[60:63], v[128:131], v[104:107]
    ds_read_b64_tr_b16 v[56:57], v15 offset:8192
    v_mfma_f32_16x16x32_bf16 v[108:111], v[60:63], v[132:135], v[108:111]
    ds_read_b64_tr_b16 v[58:59], v15 offset:9216
    v_mfma_f32_16x16x32_bf16 v[112:115], v[64:67], v[128:131], v[112:115]
    ds_read_b64_tr_b16 v[60:61], v16 offset:8192
    ds_read2_b32 v[40:41], v2 offset0:5 offset1:57
    v_mfma_f32_16x16x32_bf16 v[116:119], v[64:67], v[132:135], v[116:119]
    ds_read_b64_tr_b16 v[62:63], v16 offset:9216
    s_waitcnt lgkmcnt(13)
    v_mfma_f32_16x16x32_bf16 v[120:123], v[68:71], v[128:131], v[120:123]
    ds_read_b64_tr_b16 v[64:65], v17 offset:8192
    v_mfma_f32_16x16x32_bf16 v[124:127], v[68:71], v[132:135], v[124:127]
    ds_read_b64_tr_b16 v[66:67], v17 offset:9216
    s_waitcnt lgkmcnt(9)
    v_mfma_f32_16x16x32_bf16 v[72:75], v[44:47], v[136:139], v[72:75]
    ds_read_b64_tr_b16 v[68:69], v18 offset:8192
    s_waitcnt lgkmcnt(4)
    v_and_b32 v40, v40, v41
    v_cmp_eq_u32 vcc, 1, v40
    s_cbranch_vccnz fu_23
fu_22:
    ds_read2_b32 v[40:41], v2 offset0:5 offset1:57
    s_waitcnt lgkmcnt(0)
    v_and_b32 v40, v40, v41
    v_cmp_eq_u32 vcc, 1, v40
    s_cbranch_vccnz fu_23
    s_add_u32 s72, s72, 1
    s_cmp_lt_u32 s72, 0x80000
    s_cbranch_scc1 fu_22
fu_23:
    v_mfma_f32_16x16x32_bf16 v[76:79], v[44:47], v[140:143], v[76:79]
    ds_read_b64 v[20:21], v20
    ds_read_b64_tr_b16 v[70:71], v18 offset:9216
    v_mfma_f32_16x16x32_bf16 v[192:195], v[44:47], v[36:39], v[192:195]
    ds_read_b128 v[128:131], v4 offset:32768
    v_mfma_f32_16x16x32_bf16 v[80:83], v[48:51], v[136:139], v[80:83]
    ds_read_b64_tr_b16 v[44:45], v12 offset:32768
    v_mfma_f32_16x16x32_bf16 v[84:87], v[48:51], v[140:143], v[84:87]
    ds_read_b64 v[22:23], v22
    ds_read_b64_tr_b16 v[46:47], v12 offset:33792
    v_mfma_f32_16x16x32_bf16 v[196:199], v[48:51], v[36:39], v[196:199]
    ds_read_b128 v[132:135], v4 offset:34816
    v_mfma_f32_16x16x32_bf16 v[88:91], v[52:55], v[136:139], v[88:91]
    ds_read_b64_tr_b16 v[48:49], v13 offset:32768
    v_mfma_f32_16x16x32_bf16 v[92:95], v[52:55], v[140:143], v[92:95]
    ds_read_b64 v[24:25], v24
    ds_read_b64_tr_b16 v[50:51], v13 offset:33792
    v_mfma_f32_16x16x32_bf16 v[96:99], v[56:59], v[136:139], v[96:99]
    ds_read_b64_tr_b16 v[52:53], v14 offset:32768
    v_mfma_f32_16x16x32_bf16 v[100:103], v[56:59], v[140:143], v[100:103]
    ds_read_b64 v[26:27], v26
    ds_read_b64_tr_b16 v[54:55], v14 offset:33792
    s_waitcnt lgkmcnt(14)
    v_mfma_f32_16x16x32_bf16 v[104:107], v[60:63], v[136:139], v[104:107]
    ds_read_b64_tr_b16 v[56:57], v15 offset:32768
    v_mfma_f32_16x16x32_bf16 v[108:111], v[60:63], v[140:143], v[108:111]
    ds_read_b64 v[28:29], v28
    ds_read_b64_tr_b16 v[58:59], v15 offset:33792
    v_mfma_f32_16x16x32_bf16 v[112:115], v[64:67], v[136:139], v[112:115]
    ds_read_b64_tr_b16 v[60:61], v16 offset:32768
    v_mfma_f32_16x16x32_bf16 v[116:119], v[64:67], v[140:143], v[116:119]
    ds_read_b64 v[30:31], v30
    ds_read_b64_tr_b16 v[62:63], v16 offset:33792
    s_waitcnt lgkmcnt(15)
    v_mfma_f32_16x16x32_bf16 v[120:123], v[68:71], v[136:139], v[120:123]
    ds_read_b64_tr_b16 v[64:65], v17 offset:32768
    ds_write_b32 v35, v210 offset:32
    v_mfma_f32_16x16x32_bf16 v[124:127], v[68:71], v[140:143], v[124:127]
    ds_read_b64 v[32:33], v32
    ds_read_b64_tr_b16 v[66:67], v17 offset:33792
    s_waitcnt lgkmcnt(13)
    v_mfma_f32_16x16x32_bf16 v[72:75], v[44:47], v[128:131], v[72:75]
    ds_read_b64_tr_b16 v[68:69], v18 offset:32768
    v_mfma_f32_16x16x32_bf16 v[76:79], v[44:47], v[132:135], v[76:79]
    s_waitcnt lgkmcnt(2)
    v_lshlrev_b32 v164, 16, v20
    ds_read_b64_tr_b16 v[70:71], v18 offset:33792
    v_mfma_f32_16x16x32_bf16 v[192:195], v[44:47], v[36:39], v[192:195]
    ds_read_b128 v[136:139], v5 offset:32768
    v_mfma_f32_16x16x32_bf16 v[80:83], v[48:51], v[128:131], v[80:83]
    ds_read_b64_tr_b16 v[44:45], v12 offset:40960
    v_mfma_f32_16x16x32_bf16 v[84:87], v[48:51], v[132:135], v[84:87]
    v_lshlrev_b32 v168, 16, v22
    ds_read_b64_tr_b16 v[46:47], v12 offset:41984
    v_mfma_f32_16x16x32_bf16 v[196:199], v[48:51], v[36:39], v[196:199]
    ds_read_b128 v[140:143], v5 offset:34816
    v_mfma_f32_16x16x32_bf16 v[88:91], v[52:55], v[128:131], v[88:91]
    ds_read_b64_tr_b16 v[48:49], v13 offset:40960
    v_mfma_f32_16x16x32_bf16 v[92:95], v[52:55], v[132:135], v[92:95]
    v_lshlrev_b32 v172, 16, v24
    ds_read_b64_tr_b16 v[50:51], v13 offset:41984
    v_mfma_f32_16x16x32_bf16 v[96:99], v[56:59], v[128:131], v[96:99]
    ds_read_b64_tr_b16 v[52:53], v14 offset:40960
    v_mfma_f32_16x16x32_bf16 v[100:103], v[56:59], v[132:135], v[100:103]
    v_lshlrev_b32 v176, 16, v26
    ds_read_b64_tr_b16 v[54:55], v14 offset:41984
    s_waitcnt lgkmcnt(10)
    v_mfma_f32_16x16x32_bf16 v[104:107], v[60:63], v[128:131], v[104:107]
    ds_read_b64_tr_b16 v[56:57], v15 offset:40960
    v_mfma_f32_16x16x32_bf16 v[108:111], v[60:63], v[132:135], v[108:111]
    v_lshlrev_b32 v180, 16, v28
    ds_read_b64_tr_b16 v[58:59], v15 offset:41984
    v_mfma_f32_16x16x32_bf16 v[112:115], v[64:67], v[128:131], v[112:115]
    ds_read_b64_tr_b16 v[60:61], v16 offset:40960
    ds_read2_b32 v[40:41], v2 offset0:6 offset1:58
    v_mfma_f32_16x16x32_bf16 v[116:119], v[64:67], v[132:135], v[116:119]
    v_lshlrev_b32 v184, 16, v30
    ds_read_b64_tr_b16 v[62:63], v16 offset:41984
    s_waitcnt lgkmcnt(13)
    v_mfma_f32_16x16x32_bf16 v[120:123], v[68:71], v[128:131], v[120:123]
    ds_read_b64_tr_b16 v[64:65], v17 offset:40960
    v_mfma_f32_16x16x32_bf16 v[124:127], v[68:71], v[132:135], v[124:127]
    v_lshlrev_b32 v188, 16, v32
    ds_read_b64_tr_b16 v[66:67], v17 offset:41984
    s_waitcnt lgkmcnt(9)
    v_mfma_f32_16x16x32_bf16 v[72:75], v[44:47], v[136:139], v[72:75]
    ds_read_b64_tr_b16 v[68:69], v18 offset:40960
    s_waitcnt lgkmcnt(4)
    v_and_b32 v40, v40, v41
    v_cmp_eq_u32 vcc, 1, v40
    s_cbranch_vccnz fu_25
fu_24:
    ds_read2_b32 v[40:41], v2 offset0:6 offset1:58
    s_waitcnt lgkmcnt(0)
    v_and_b32 v40, v40, v41
    v_cmp_eq_u32 vcc, 1, v40
    s_cbranch_vccnz fu_25
    s_add_u32 s72, s72, 1
    s_cmp_lt_u32 s72, 0x80000
    s_cbranch_scc1 fu_24
fu_25:
    v_xor_b32 v4, 0x10000, v4
    v_xor_b32 v5, 0x10000, v5
    v_xor_b32 v12, 0x10000, v12
    v_mfma_f32_16x16x32_bf16 v[76:79], v[44:47], v[140:143], v[76:79]
    ds_read_b64_tr_b16 v[70:71], v18 offset:41984
    v_mfma_f32_16x16x32_bf16 v[192:195], v[44:47], v[36:39], v[192:195]
    ds_read_b128 v[128:131], v4 offset:0
    v_mfma_f32_16x16x32_bf16 v[80:83], v[48:51], v[136:139], v[80:83]
    ds_read_b64_tr_b16 v[44:45], v12 offset:0
    v_xor_b32 v13, 0x10000, v13
    v_mfma_f32_16x16x32_bf16 v[84:87], v[48:51], v[140:143], v[84:87]
    ds_read_b64_tr_b16 v[46:47], v12 offset:1024
    v_mfma_f32_16x16x32_bf16 v[196:199], v[48:51], v[36:39], v[196:199]
    ds_read_b128 v[132:135], v4 offset:2048
    v_mfma_f32_16x16x32_bf16 v[88:91], v[52:55], v[136:139], v[88:91]
    ds_read_b64_tr_b16 v[48:49], v13 offset:0
    v_xor_b32 v14, 0x10000, v14
    v_mfma_f32_16x16x32_bf16 v[92:95], v[52:55], v[140:143], v[92:95]
    ds_read_b64_tr_b16 v[50:51], v13 offset:1024
    v_mfma_f32_16x16x32_bf16 v[96:99], v[56:59], v[136:139], v[96:99]
    ds_read_b64_tr_b16 v[52:53], v14 offset:0
    v_xor_b32 v15, 0x10000, v15
    v_mfma_f32_16x16x32_bf16 v[100:103], v[56:59], v[140:143], v[100:103]
    ds_read_b64_tr_b16 v[54:55], v14 offset:1024
    s_waitcnt lgkmcnt(10)
    v_mfma_f32_16x16x32_bf16 v[104:107], v[60:63], v[136:139], v[104:107]
    ds_read_b64_tr_b16 v[56:57], v15 offset:0
    v_xor_b32 v16, 0x10000, v16
    v_mfma_f32_16x16x32_bf16 v[108:111], v[60:63], v[140:143], v[108:111]
    ds_read_b64_tr_b16 v[58:59], v15 offset:1024
    v_mfma_f32_16x16x32_bf16 v[112:115], v[64:67], v[136:139], v[112:115]
    ds_read_b64_tr_b16 v[60:61], v16 offset:0
    v_xor_b32 v17, 0x10000, v17
    v_mfma_f32_16x16x32_bf16 v[116:119], v[64:67], v[140:143], v[116:119]
    ds_read_b64_tr_b16 v[62:63], v16 offset:1024
    s_waitcnt lgkmcnt(12)
    v_mfma_f32_16x16x32_bf16 v[120:123], v[68:71], v[136:139], v[120:123]
    ds_read_b64_tr_b16 v[64:65], v17 offset:0
    v_xor_b32 v18, 0x10000, v18
    ds_write_b32 v35, v211 offset:32
    v_mfma_f32_16x16x32_bf16 v[124:127], v[68:71], v[140:143], v[124:127]
    ds_read_b64_tr_b16 v[66:67], v17 offset:1024
    s_waitcnt lgkmcnt(9)
    v_mfma_f32_16x16x32_bf16 v[72:75], v[44:47], v[128:131], v[72:75]
    ds_read_b64_tr_b16 v[68:69], v18 offset:0
    v_mfma_f32_16x16x32_bf16 v[76:79], v[44:47], v[132:135], v[76:79]
    v_and_b32 v165, 0xffff0000, v20
    ds_read_b64_tr_b16 v[70:71], v18 offset:1024
    v_mfma_f32_16x16x32_bf16 v[192:195], v[44:47], v[36:39], v[192:195]
    ds_read_b128 v[136:139], v5 offset:0
    v_mfma_f32_16x16x32_bf16 v[80:83], v[48:51], v[128:131], v[80:83]
    ds_read_b64_tr_b16 v[44:45], v12 offset:8192
    v_mfma_f32_16x16x32_bf16 v[84:87], v[48:51], v[132:135], v[84:87]
    v_and_b32 v169, 0xffff0000, v22
    ds_read_b64_tr_b16 v[46:47], v12 offset:9216
    v_mfma_f32_16x16x32_bf16 v[196:199], v[48:51], v[36:39], v[196:199]
    ds_read_b128 v[140:143], v5 offset:2048
    s_waitcnt lgkmcnt(11)
    v_mfma_f32_16x16x32_bf16 v[88:91], v[52:55], v[128:131], v[88:91]
    ds_read_b64_tr_b16 v[48:49], v13 offset:8192
    v_mfma_f32_16x16x32_bf16 v[92:95], v[52:55], v[132:135], v[92:95]
    v_and_b32 v173, 0xffff0000, v24
    ds_read_b64_tr_b16 v[50:51], v13 offset:9216
    v_mfma_f32_16x16x32_bf16 v[96:99], v[56:59], v[128:131], v[96:99]
    ds_read_b64_tr_b16 v[52:53], v14 offset:8192
    v_mfma_f32_16x16x32_bf16 v[100:103], v[56:59], v[132:135], v[100:103]
    v_and_b32 v177, 0xffff0000, v26
    ds_read_b64_tr_b16 v[54:55], v14 offset:9216
    s_waitcnt lgkmcnt(10)
    v_mfma_f32_16x16x32_bf16 v[104:107], v[60:63], v[128:131], v[104:107]
    ds_read_b64_tr_b16 v[56:57], v15 offset:8192
    v_mfma_f32_16x16x32_bf16 v[108:111], v[60:63], v[132:135], v[108:111]
    v_and_b32 v181, 0xffff0000, v28
    ds_read_b64_tr_b16 v[58:59], v15 offset:9216
    v_mfma_f32_16x16x32_bf16 v[112:115], v[64:67], v[128:131], v[112:115]
    ds_read_b64_tr_b16 v[60:61], v16 offset:8192
    ds_read2_b32 v[40:41], v2 offset0:7 offset1:59
    v_mfma_f32_16x16x32_bf16 v[116:119], v[64:67], v[132:135], v[116:119]
    v_and_b32 v185, 0xffff0000, v30
    ds_read_b64_tr_b16 v[62:63], v16 offset:9216
    s_waitcnt lgkmcnt(13)
    v_mfma_f32_16x16x32_bf16 v[120:123], v[68:71], v[128:131], v[120:123]
    ds_read_b64_tr_b16 v[64:65], v17 offset:8192
    v_mfma_f32_16x16x32_bf16 v[124:127], v[68:71], v[132:135], v[124:127]
    v_and_b32 v189, 0xffff0000, v32
    ds_read_b64_tr_b16 v[66:67], v17 offset:9216
    s_waitcnt lgkmcnt(9)
    v_mfma_f32_16x16x32_bf16 v[72:75], v[44:47], v[136:139], v[72:75]
    ds_read_b64_tr_b16 v[68:69], v18 offset:8192
    s_waitcnt lgkmcnt(4)
    v_and_b32 v40, v40, v41
    v_cmp_eq_u32 vcc, 1, v40
    s_cbranch_vccnz fu_27
fu_26:
    ds_read2_b32 v[40:41], v2 offset0:7 offset1:59
    s_waitcnt lgkmcnt(0)
    v_and_b32 v40, v40, v41
    v_cmp_eq_u32 vcc, 1, v40
    s_cbranch_vccnz fu_27
    s_add_u32 s72, s72, 1
    s_cmp_lt_u32 s72, 0x80000
    s_cbranch_scc1 fu_26
fu_27:
    v_mfma_f32_16x16x32_bf16 v[76:79], v[44:47], v[140:143], v[76:79]
    v_lshlrev_b32 v166, 16, v21
    ds_read_b64_tr_b16 v[70:71], v18 offset:9216
    v_mfma_f32_16x16x32_bf16 v[192:195], v[44:47], v[36:39], v[192:195]
    ds_read_b128 v[128:131], v4 offset:32768
    v_mfma_f32_16x16x32_bf16 v[80:83], v[48:51], v[136:139], v[80:83]
    ds_read_b64_tr_b16 v[44:45], v12 offset:32768
    v_mfma_f32_16x16x32_bf16 v[84:87], v[48:51], v[140:143], v[84:87]
    v_lshlrev_b32 v170, 16, v23
    ds_read_b64_tr_b16 v[46:47], v12 offset:33792
    v_mfma_f32_16x16x32_bf16 v[196:199], v[48:51], v[36:39], v[196:199]
    ds_read_b128 v[132:135], v4 offset:34816
    v_mfma_f32_16x16x32_bf16 v[88:91], v[52:55], v[136:139], v[88:91]
    ds_read_b64_tr_b16 v[48:49], v13 offset:32768
    v_mfma_f32_16x16x32_bf16 v[92:95], v[52:55], v[140:143], v[92:95]
    v_lshlrev_b32 v174, 16, v25
    ds_read_b64_tr_b16 v[50:51], v13 offset:33792
    v_mfma_f32_16x16x32_bf16 v[96:99], v[56:59], v[136:139], v[96:99]
    ds_read_b64_tr_b16 v[52:53], v14 offset:32768
    v_mfma_f32_16x16x32_bf16 v[100:103], v[56:59], v[140:143], v[100:103]
    v_lshlrev_b32 v178, 16, v27
    ds_read_b64_tr_b16 v[54:55], v14 offset:33792
    s_waitcnt lgkmcnt(10)
    v_mfma_f32_16x16x32_bf16 v[104:107], v[60:63], v[136:139], v[104:107]
    ds_read_b64_tr_b16 v[56:57], v15 offset:32768
    v_mfma_f32_16x16x32_bf16 v[108:111], v[60:63], v[140:143], v[108:111]
    v_lshlrev_b32 v182, 16, v29
    ds_read_b64_tr_b16 v[58:59], v15 offset:33792
    v_mfma_f32_16x16x32_bf16 v[112:115], v[64:67], v[136:139], v[112:115]
    ds_read_b64_tr_b16 v[60:61], v16 offset:32768
    v_mfma_f32_16x16x32_bf16 v[116:119], v[64:67], v[140:143], v[116:119]
    v_lshlrev_b32 v186, 16, v31
    ds_read_b64_tr_b16 v[62:63], v16 offset:33792
    s_waitcnt lgkmcnt(12)
    v_mfma_f32_16x16x32_bf16 v[120:123], v[68:71], v[136:139], v[120:123]
    ds_read_b64_tr_b16 v[64:65], v17 offset:32768
    ds_write_b32 v35, v212 offset:32
    v_mfma_f32_16x16x32_bf16 v[124:127], v[68:71], v[140:143], v[124:127]
    v_lshlrev_b32 v190, 16, v33
    ds_read_b64_tr_b16 v[66:67], v17 offset:33792
    s_waitcnt lgkmcnt(9)
    v_mfma_f32_16x16x32_bf16 v[72:75], v[44:47], v[128:131], v[72:75]
    ds_read_b64_tr_b16 v[68:69], v18 offset:32768
    v_mfma_f32_16x16x32_bf16 v[76:79], v[44:47], v[132:135], v[76:79]
    v_and_b32 v167, 0xffff0000, v21
    ds_read_b64_tr_b16 v[70:71], v18 offset:33792
    v_mfma_f32_16x16x32_bf16 v[192:195], v[44:47], v[36:39], v[192:195]
    ds_read_b128 v[136:139], v5 offset:32768
    v_mfma_f32_16x16x32_bf16 v[80:83], v[48:51], v[128:131], v[80:83]
    ds_read_b64_tr_b16 v[44:45], v12 offset:40960
    v_mfma_f32_16x16x32_bf16 v[84:87], v[48:51], v[132:135], v[84:87]
    v_and_b32 v171, 0xffff0000, v23
    ds_read_b64_tr_b16 v[46:47], v12 offset:41984
    v_mfma_f32_16x16x32_bf16 v[196:199], v[48:51], v[36:39], v[196:199]
    ds_read_b128 v[140:143], v5 offset:34816
    s_waitcnt lgkmcnt(11)
    v_mfma_f32_16x16x32_bf16 v[88:91], v[52:55], v[128:131], v[88:91]
    ds_read_b64_tr_b16 v[48:49], v13 offset:40960
    v_mfma_f32_16x16x32_bf16 v[92:95], v[52:55], v[132:135], v[92:95]
    v_and_b32 v175, 0xffff0000, v25
    ds_read_b64_tr_b16 v[50:51], v13 offset:41984
    v_mfma_f32_16x16x32_bf16 v[96:99], v[56:59], v[128:131], v[96:99]
    ds_read_b64_tr_b16 v[52:53], v14 offset:40960
    v_mfma_f32_16x16x32_bf16 v[100:103], v[56:59], v[132:135], v[100:103]
    v_and_b32 v179, 0xffff0000, v27
    ds_read_b64_tr_b16 v[54:55], v14 offset:41984
    s_waitcnt lgkmcnt(10)
    v_mfma_f32_16x16x32_bf16 v[104:107], v[60:63], v[128:131], v[104:107]
    ds_read_b64_tr_b16 v[56:57], v15 offset:40960
    v_mfma_f32_16x16x32_bf16 v[108:111], v[60:63], v[132:135], v[108:111]
    v_and_b32 v183, 0xffff0000, v29
    ds_read_b64_tr_b16 v[58:59], v15 offset:41984
    v_mfma_f32_16x16x32_bf16 v[112:115], v[64:67], v[128:131], v[112:115]
    ds_read_b64_tr_b16 v[60:61], v16 offset:40960
    v_mfma_f32_16x16x32_bf16 v[116:119], v[64:67], v[132:135], v[116:119]
    v_and_b32 v187, 0xffff0000, v31
    ds_read_b64_tr_b16 v[62:63], v16 offset:41984
    s_waitcnt lgkmcnt(12)
    v_mfma_f32_16x16x32_bf16 v[120:123], v[68:71], v[128:131], v[120:123]
    ds_read_b64_tr_b16 v[64:65], v17 offset:40960
    v_mfma_f32_16x16x32_bf16 v[124:127], v[68:71], v[132:135], v[124:127]
    v_and_b32 v191, 0xffff0000, v33
    ds_read_b64_tr_b16 v[66:67], v17 offset:41984
    s_waitcnt lgkmcnt(8)
    v_mfma_f32_16x16x32_bf16 v[72:75], v[44:47], v[136:139], v[72:75]
    ds_read_b64_tr_b16 v[68:69], v18 offset:40960
    v_mfma_f32_16x16x32_bf16 v[76:79], v[44:47], v[140:143], v[76:79]
    ds_read_b64_tr_b16 v[70:71], v18 offset:41984
    v_mfma_f32_16x16x32_bf16 v[192:195], v[44:47], v[36:39], v[192:195]
    v_mfma_f32_16x16x32_bf16 v[80:83], v[48:51], v[136:139], v[80:83]
    v_mfma_f32_16x16x32_bf16 v[84:87], v[48:51], v[140:143], v[84:87]
    v_mfma_f32_16x16x32_bf16 v[196:199], v[48:51], v[36:39], v[196:199]
    s_waitcnt lgkmcnt(6)
    v_mfma_f32_16x16x32_bf16 v[88:91], v[52:55], v[136:139], v[88:91]
    v_mfma_f32_16x16x32_bf16 v[92:95], v[52:55], v[140:143], v[92:95]
    v_mfma_f32_16x16x32_bf16 v[96:99], v[56:59], v[136:139], v[96:99]
    v_mfma_f32_16x16x32_bf16 v[100:103], v[56:59], v[140:143], v[100:103]
    s_waitcnt lgkmcnt(2)
    v_mfma_f32_16x16x32_bf16 v[104:107], v[60:63], v[136:139], v[104:107]
    v_mfma_f32_16x16x32_bf16 v[108:111], v[60:63], v[140:143], v[108:111]
    ds_write_b128 v226, v[192:195]
    ds_write_b128 v227, v[196:199]
    ds_write_b32 v35, v34 offset:128
    v_mfma_f32_16x16x32_bf16 v[112:115], v[64:67], v[136:139], v[112:115]
    v_mfma_f32_16x16x32_bf16 v[116:119], v[64:67], v[140:143], v[116:119]
    s_waitcnt lgkmcnt(3)
    v_mfma_f32_16x16x32_bf16 v[120:123], v[68:71], v[136:139], v[120:123]
    ds_write_b32 v35, v213 offset:32
    v_mfma_f32_16x16x32_bf16 v[124:127], v[68:71], v[140:143], v[124:127]
ep_28:
    ds_read_b128 v[40:43], v2 offset:128
    ds_read_b32 v6, v2 offset:144
    s_waitcnt lgkmcnt(0)
    v_min3_u32 v40, v40, v41, v6
    v_min3_u32 v40, v40, v42, v43
    v_cmp_eq_u32 vcc, 1, v40
    s_cbranch_vccnz ep_28_d
    s_add_u32 s72, s72, 1
    s_cmp_lt_u32 s72, 0x80000
    s_cbranch_scc1 ep_28
ep_28_d:
    ds_read_b64 v[152:153], v160 offset:0
    ds_read_b64 v[156:157], v160 offset:128
    ds_read_b128 v[44:47], v226
    ds_read_b128 v[48:51], v227
    ds_read_b128 v[52:55], v228
    ds_read_b128 v[56:59], v229
    ds_read_b128 v[60:63], v230
    ds_read_b128 v[64:67], v231
    ds_read_b128 v[68:71], v232
    s_waitcnt lgkmcnt(7)
    v_mov_b32 v154, v153
    v_mov_b32 v158, v157
    s_waitcnt lgkmcnt(6)
    s_waitcnt lgkmcnt(5)
    v_pk_fma_f32 v[72:73], v[44:45], v[152:153], v[72:73] op_sel_hi:[1,0,1]
    v_pk_fma_f32 v[74:75], v[46:47], v[152:153], v[74:75] op_sel_hi:[1,0,1]
    v_pk_fma_f32 v[80:81], v[48:49], v[152:153], v[80:81] op_sel_hi:[1,0,1]
    v_pk_fma_f32 v[82:83], v[50:51], v[152:153], v[82:83] op_sel_hi:[1,0,1]
    v_pk_fma_f32 v[72:73], v[72:73], v[154:155], v[164:165] op_sel_hi:[1,0,1]
    v_pk_fma_f32 v[74:75], v[74:75], v[154:155], v[166:167] op_sel_hi:[1,0,1]
    v_pk_fma_f32 v[80:81], v[80:81], v[154:155], v[168:169] op_sel_hi:[1,0,1]
    v_pk_fma_f32 v[82:83], v[82:83], v[154:155], v[170:171] op_sel_hi:[1,0,1]
    v_pk_mul_f32 v[236:237], v[72:73], v[72:73]
    v_pk_mul_f32 v[238:239], v[74:75], v[74:75]
    v_pk_mul_f32 v[240:241], v[80:81], v[80:81]
    v_pk_mul_f32 v[242:243], v[82:83], v[82:83]
    v_pk_fma_f32 v[236:237], v[236:237], v[220:221], v[222:223] op_sel_hi:[1,0,0]
    v_pk_fma_f32 v[238:239], v[238:239], v[220:221], v[222:223] op_sel_hi:[1,0,0]
    v_pk_fma_f32 v[240:241], v[240:241], v[220:221], v[222:223] op_sel_hi:[1,0,0]
    v_pk_fma_f32 v[242:243], v[242:243], v[220:221], v[222:223] op_sel_hi:[1,0,0]
    v_pk_mul_f32 v[236:237], v[236:237], v[72:73]
    v_pk_mul_f32 v[238:239], v[238:239], v[74:75]
    v_pk_mul_f32 v[240:241], v[240:241], v[80:81]
    v_pk_mul_f32 v[242:243], v[242:243], v[82:83]
    v_exp_f32 v236, v236
    v_exp_f32 v238, v238
    v_exp_f32 v240, v240
    v_exp_f32 v242, v242
    v_exp_f32 v237, v237
    v_exp_f32 v239, v239
    v_exp_f32 v241, v241
    v_exp_f32 v243, v243
    v_pk_add_f32 v[236:237], v[236:237], v[224:225] op_sel_hi:[1,0]
    v_pk_add_f32 v[238:239], v[238:239], v[224:225] op_sel_hi:[1,0]
    v_pk_add_f32 v[240:241], v[240:241], v[224:225] op_sel_hi:[1,0]
    v_pk_add_f32 v[242:243], v[242:243], v[224:225] op_sel_hi:[1,0]
    v_rcp_f32 v236, v236
    v_rcp_f32 v238, v238
    v_rcp_f32 v240, v240
    v_rcp_f32 v242, v242
    v_rcp_f32 v237, v237
    v_rcp_f32 v239, v239
    v_rcp_f32 v241, v241
    v_rcp_f32 v243, v243
    v_pk_mul_f32 v[236:237], v[236:237], v[72:73]
    v_pk_mul_f32 v[238:239], v[238:239], v[74:75]
    v_pk_mul_f32 v[240:241], v[240:241], v[80:81]
    v_pk_mul_f32 v[242:243], v[242:243], v[82:83]
    v_cvt_pk_bf16_f32 v192, v236, v237
    v_cvt_pk_bf16_f32 v193, v238, v239
    v_cvt_pk_bf16_f32 v194, v240, v241
    v_cvt_pk_bf16_f32 v195, v242, v243
    s_nop 0
    v_permlane16_swap_b32 v192, v194
    v_permlane16_swap_b32 v193, v195
    buffer_store_dwordx4 v[192:195], v216, s[44:47], 0 offen sc1
    s_waitcnt lgkmcnt(4)
    s_waitcnt lgkmcnt(3)
    v_pk_fma_f32 v[88:89], v[52:53], v[152:153], v[88:89] op_sel_hi:[1,0,1]
    v_pk_fma_f32 v[90:91], v[54:55], v[152:153], v[90:91] op_sel_hi:[1,0,1]
    v_pk_fma_f32 v[96:97], v[56:57], v[152:153], v[96:97] op_sel_hi:[1,0,1]
    v_pk_fma_f32 v[98:99], v[58:59], v[152:153], v[98:99] op_sel_hi:[1,0,1]
    v_pk_fma_f32 v[88:89], v[88:89], v[154:155], v[172:173] op_sel_hi:[1,0,1]
    v_pk_fma_f32 v[90:91], v[90:91], v[154:155], v[174:175] op_sel_hi:[1,0,1]
    v_pk_fma_f32 v[96:97], v[96:97], v[154:155], v[176:177] op_sel_hi:[1,0,1]
    v_pk_fma_f32 v[98:99], v[98:99], v[154:155], v[178:179] op_sel_hi:[1,0,1]
    v_pk_mul_f32 v[236:237], v[88:89], v[88:89]
    v_pk_mul_f32 v[238:239], v[90:91], v[90:91]
    v_pk_mul_f32 v[240:241], v[96:97], v[96:97]
    v_pk_mul_f32 v[242:243], v[98:99], v[98:99]
    v_pk_fma_f32 v[236:237], v[236:237], v[220:221], v[222:223] op_sel_hi:[1,0,0]
    v_pk_fma_f32 v[238:239], v[238:239], v[220:221], v[222:223] op_sel_hi:[1,0,0]
    v_pk_fma_f32 v[240:241], v[240:241], v[220:221], v[222:223] op_sel_hi:[1,0,0]
    v_pk_fma_f32 v[242:243], v[242:243], v[220:221], v[222:223] op_sel_hi:[1,0,0]
    v_pk_mul_f32 v[236:237], v[236:237], v[88:89]
    v_pk_mul_f32 v[238:239], v[238:239], v[90:91]
    v_pk_mul_f32 v[240:241], v[240:241], v[96:97]
    v_pk_mul_f32 v[242:243], v[242:243], v[98:99]
    v_exp_f32 v236, v236
    v_exp_f32 v238, v238
    v_exp_f32 v240, v240
    v_exp_f32 v242, v242
    v_exp_f32 v237, v237
    v_exp_f32 v239, v239
    v_exp_f32 v241, v241
    v_exp_f32 v243, v243
    v_pk_add_f32 v[236:237], v[236:237], v[224:225] op_sel_hi:[1,0]
    v_pk_add_f32 v[238:239], v[238:239], v[224:225] op_sel_hi:[1,0]
    v_pk_add_f32 v[240:241], v[240:241], v[224:225] op_sel_hi:[1,0]
    v_pk_add_f32 v[242:243], v[242:243], v[224:225] op_sel_hi:[1,0]
    v_rcp_f32 v236, v236
    v_rcp_f32 v238, v238
    v_rcp_f32 v240, v240
    v_rcp_f32 v242, v242
    v_rcp_f32 v237, v237
    v_rcp_f32 v239, v239
    v_rcp_f32 v241, v241
    v_rcp_f32 v243, v243
    v_pk_mul_f32 v[236:237], v[236:237], v[88:89]
    v_pk_mul_f32 v[238:239], v[238:239], v[90:91]
    v_pk_mul_f32 v[240:241], v[240:241], v[96:97]
    v_pk_mul_f32 v[242:243], v[242:243], v[98:99]
    v_cvt_pk_bf16_f32 v196, v236, v237
    v_cvt_pk_bf16_f32 v197, v238, v239
    v_cvt_pk_bf16_f32 v198, v240, v241
    v_cvt_pk_bf16_f32 v199, v242, v243
    s_nop 0
    v_permlane16_swap_b32 v196, v198
    v_permlane16_swap_b32 v197, v199
    buffer_store_dwordx4 v[196:199], v217, s[44:47], 0 offen sc1
    s_waitcnt lgkmcnt(2)
    s_waitcnt lgkmcnt(1)
    v_pk_fma_f32 v[104:105], v[60:61], v[152:153], v[104:105] op_sel_hi:[1,0,1]
    v_pk_fma_f32 v[106:107], v[62:63], v[152:153], v[106:107] op_sel_hi:[1,0,1]
    v_pk_fma_f32 v[112:113], v[64:65], v[152:153], v[112:113] op_sel_hi:[1,0,1]
    v_pk_fma_f32 v[114:115], v[66:67], v[152:153], v[114:115] op_sel_hi:[1,0,1]
    v_pk_fma_f32 v[104:105], v[104:105], v[154:155], v[180:181] op_sel_hi:[1,0,1]
    v_pk_fma_f32 v[106:107], v[106:107], v[154:155], v[182:183] op_sel_hi:[1,0,1]
    v_pk_fma_f32 v[112:113], v[112:113], v[154:155], v[184:185] op_sel_hi:[1,0,1]
    v_pk_fma_f32 v[114:115], v[114:115], v[154:155], v[186:187] op_sel_hi:[1,0,1]
    v_pk_mul_f32 v[236:237], v[104:105], v[104:105]
    v_pk_mul_f32 v[238:239], v[106:107], v[106:107]
    v_pk_mul_f32 v[240:241], v[112:113], v[112:113]
    v_pk_mul_f32 v[242:243], v[114:115], v[114:115]
    v_pk_fma_f32 v[236:237], v[236:237], v[220:221], v[222:223] op_sel_hi:[1,0,0]
    v_pk_fma_f32 v[238:239], v[238:239], v[220:221], v[222:223] op_sel_hi:[1,0,0]
    v_pk_fma_f32 v[240:241], v[240:241], v[220:221], v[222:223] op_sel_hi:[1,0,0]
    v_pk_fma_f32 v[242:243], v[242:243], v[220:221], v[222:223] op_sel_hi:[1,0,0]
    v_pk_mul_f32 v[236:237], v[236:237], v[104:105]
    v_pk_mul_f32 v[238:239], v[238:239], v[106:107]
    v_pk_mul_f32 v[240:241], v[240:241], v[112:113]
    v_pk_mul_f32 v[242:243], v[242:243], v[114:115]
    v_exp_f32 v236, v236
    v_exp_f32 v238, v238
    v_exp_f32 v240, v240
    v_exp_f32 v242, v242
    v_exp_f32 v237, v237
    v_exp_f32 v239, v239
    v_exp_f32 v241, v241
    v_exp_f32 v243, v243
    v_pk_add_f32 v[236:237], v[236:237], v[224:225] op_sel_hi:[1,0]
    v_pk_add_f32 v[238:239], v[238:239], v[224:225] op_sel_hi:[1,0]
    v_pk_add_f32 v[240:241], v[240:241], v[224:225] op_sel_hi:[1,0]
    v_pk_add_f32 v[242:243], v[242:243], v[224:225] op_sel_hi:[1,0]
    v_rcp_f32 v236, v236
    v_rcp_f32 v238, v238
    v_rcp_f32 v240, v240
    v_rcp_f32 v242, v242
    v_rcp_f32 v237, v237
    v_rcp_f32 v239, v239
    v_rcp_f32 v241, v241
    v_rcp_f32 v243, v243
    v_pk_mul_f32 v[236:237], v[236:237], v[104:105]
    v_pk_mul_f32 v[238:239], v[238:239], v[106:107]
    v_pk_mul_f32 v[240:241], v[240:241], v[112:113]
    v_pk_mul_f32 v[242:243], v[242:243], v[114:115]
    v_cvt_pk_bf16_f32 v200, v236, v237
    v_cvt_pk_bf16_f32 v201, v238, v239
    v_cvt_pk_bf16_f32 v202, v240, v241
    v_cvt_pk_bf16_f32 v203, v242, v243
    s_nop 0
    v_permlane16_swap_b32 v200, v202
    v_permlane16_swap_b32 v201, v203
    buffer_store_dwordx4 v[200:203], v218, s[44:47], 0 offen sc1
    s_waitcnt lgkmcnt(0)
    v_pk_fma_f32 v[120:121], v[68:69], v[152:153], v[120:121] op_sel_hi:[1,0,1]
    v_pk_fma_f32 v[122:123], v[70:71], v[152:153], v[122:123] op_sel_hi:[1,0,1]
    v_pk_fma_f32 v[124:125], v[68:69], v[156:157], v[124:125] op_sel_hi:[1,0,1]
    v_pk_fma_f32 v[126:127], v[70:71], v[156:157], v[126:127] op_sel_hi:[1,0,1]
    v_pk_fma_f32 v[120:121], v[120:121], v[154:155], v[188:189] op_sel_hi:[1,0,1]
    v_pk_fma_f32 v[122:123], v[122:123], v[154:155], v[190:191] op_sel_hi:[1,0,1]
    v_pk_fma_f32 v[124:125], v[124:125], v[158:159], v[188:189] op_sel_hi:[1,0,1]
    v_pk_fma_f32 v[126:127], v[126:127], v[158:159], v[190:191] op_sel_hi:[1,0,1]
    v_pk_mul_f32 v[236:237], v[120:121], v[120:121]
    v_pk_mul_f32 v[238:239], v[122:123], v[122:123]
    v_pk_mul_f32 v[240:241], v[124:125], v[124:125]
    v_pk_mul_f32 v[242:243], v[126:127], v[126:127]
    v_pk_fma_f32 v[236:237], v[236:237], v[220:221], v[222:223] op_sel_hi:[1,0,0]
    v_pk_fma_f32 v[238:239], v[238:239], v[220:221], v[222:223] op_sel_hi:[1,0,0]
    v_pk_fma_f32 v[240:241], v[240:241], v[220:221], v[222:223] op_sel_hi:[1,0,0]
    v_pk_fma_f32 v[242:243], v[242:243], v[220:221], v[222:223] op_sel_hi:[1,0,0]
    v_pk_mul_f32 v[236:237], v[236:237], v[120:121]
    v_pk_mul_f32 v[238:239], v[238:239], v[122:123]
    v_pk_mul_f32 v[240:241], v[240:241], v[124:125]
    v_pk_mul_f32 v[242:243], v[242:243], v[126:127]
    v_exp_f32 v236, v236
    v_exp_f32 v238, v238
    v_exp_f32 v240, v240
    v_exp_f32 v242, v242
    v_exp_f32 v237, v237
    v_exp_f32 v239, v239
    v_exp_f32 v241, v241
    v_exp_f32 v243, v243
    v_pk_add_f32 v[236:237], v[236:237], v[224:225] op_sel_hi:[1,0]
    v_pk_add_f32 v[238:239], v[238:239], v[224:225] op_sel_hi:[1,0]
    v_pk_add_f32 v[240:241], v[240:241], v[224:225] op_sel_hi:[1,0]
    v_pk_add_f32 v[242:243], v[242:243], v[224:225] op_sel_hi:[1,0]
    v_rcp_f32 v236, v236
    v_rcp_f32 v238, v238
    v_rcp_f32 v240, v240
    v_rcp_f32 v242, v242
    v_rcp_f32 v237, v237
    v_rcp_f32 v239, v239
    v_rcp_f32 v241, v241
    v_rcp_f32 v243, v243
    v_pk_mul_f32 v[236:237], v[236:237], v[120:121]
    v_pk_mul_f32 v[238:239], v[238:239], v[122:123]
    v_pk_mul_f32 v[240:241], v[240:241], v[124:125]
    v_pk_mul_f32 v[242:243], v[242:243], v[126:127]
    v_cvt_pk_bf16_f32 v204, v236, v237
    v_cvt_pk_bf16_f32 v205, v238, v239
    v_cvt_pk_bf16_f32 v206, v240, v241
    v_cvt_pk_bf16_f32 v207, v242, v243
    s_nop 0
    v_permlane16_swap_b32 v204, v206
    v_permlane16_swap_b32 v205, v207
    buffer_store_dwordx4 v[204:207], v219, s[44:47], 0 offen sc1
    v_pk_fma_f32 v[76:77], v[44:45], v[156:157], v[76:77] op_sel_hi:[1,0,1]
    v_pk_fma_f32 v[78:79], v[46:47], v[156:157], v[78:79] op_sel_hi:[1,0,1]
    v_pk_fma_f32 v[84:85], v[48:49], v[156:157], v[84:85] op_sel_hi:[1,0,1]
    v_pk_fma_f32 v[86:87], v[50:51], v[156:157], v[86:87] op_sel_hi:[1,0,1]
    v_pk_fma_f32 v[76:77], v[76:77], v[158:159], v[164:165] op_sel_hi:[1,0,1]
    v_pk_fma_f32 v[78:79], v[78:79], v[158:159], v[166:167] op_sel_hi:[1,0,1]
    v_pk_fma_f32 v[84:85], v[84:85], v[158:159], v[168:169] op_sel_hi:[1,0,1]
    v_pk_fma_f32 v[86:87], v[86:87], v[158:159], v[170:171] op_sel_hi:[1,0,1]
    v_pk_mul_f32 v[236:237], v[76:77], v[76:77]
    v_pk_mul_f32 v[238:239], v[78:79], v[78:79]
    v_pk_mul_f32 v[240:241], v[84:85], v[84:85]
    v_pk_mul_f32 v[242:243], v[86:87], v[86:87]
    v_pk_fma_f32 v[236:237], v[236:237], v[220:221], v[222:223] op_sel_hi:[1,0,0]
    v_pk_fma_f32 v[238:239], v[238:239], v[220:221], v[222:223] op_sel_hi:[1,0,0]
    v_pk_fma_f32 v[240:241], v[240:241], v[220:221], v[222:223] op_sel_hi:[1,0,0]
    v_pk_fma_f32 v[242:243], v[242:243], v[220:221], v[222:223] op_sel_hi:[1,0,0]
    v_pk_mul_f32 v[236:237], v[236:237], v[76:77]
    v_pk_mul_f32 v[238:239], v[238:239], v[78:79]
    v_pk_mul_f32 v[240:241], v[240:241], v[84:85]
    v_pk_mul_f32 v[242:243], v[242:243], v[86:87]
    v_exp_f32 v236, v236
    v_exp_f32 v238, v238
    v_exp_f32 v240, v240
    v_exp_f32 v242, v242
    v_exp_f32 v237, v237
    v_exp_f32 v239, v239
    v_exp_f32 v241, v241
    v_exp_f32 v243, v243
    v_pk_add_f32 v[236:237], v[236:237], v[224:225] op_sel_hi:[1,0]
    v_pk_add_f32 v[238:239], v[238:239], v[224:225] op_sel_hi:[1,0]
    v_pk_add_f32 v[240:241], v[240:241], v[224:225] op_sel_hi:[1,0]
    v_pk_add_f32 v[242:243], v[242:243], v[224:225] op_sel_hi:[1,0]
    v_rcp_f32 v236, v236
    v_rcp_f32 v238, v238
    v_rcp_f32 v240, v240
    v_rcp_f32 v242, v242
    v_rcp_f32 v237, v237
    v_rcp_f32 v239, v239
    v_rcp_f32 v241, v241
    v_rcp_f32 v243, v243
    v_pk_mul_f32 v[236:237], v[236:237], v[76:77]
    v_pk_mul_f32 v[238:239], v[238:239], v[78:79]
    v_pk_mul_f32 v[240:241], v[240:241], v[84:85]
    v_pk_mul_f32 v[242:243], v[242:243], v[86:87]
    v_cvt_pk_bf16_f32 v192, v236, v237
    v_cvt_pk_bf16_f32 v193, v238, v239
    v_cvt_pk_bf16_f32 v194, v240, v241
    v_cvt_pk_bf16_f32 v195, v242, v243
    s_nop 0
    v_permlane16_swap_b32 v192, v194
    v_permlane16_swap_b32 v193, v195
    buffer_store_dwordx4 v[192:195], v216, s[44:47], s59 offen sc1
    v_pk_fma_f32 v[92:93], v[52:53], v[156:157], v[92:93] op_sel_hi:[1,0,1]
    v_pk_fma_f32 v[94:95], v[54:55], v[156:157], v[94:95] op_sel_hi:[1,0,1]
    v_pk_fma_f32 v[100:101], v[56:57], v[156:157], v[100:101] op_sel_hi:[1,0,1]
    v_pk_fma_f32 v[102:103], v[58:59], v[156:157], v[102:103] op_sel_hi:[1,0,1]
    v_pk_fma_f32 v[92:93], v[92:93], v[158:159], v[172:173] op_sel_hi:[1,0,1]
    v_pk_fma_f32 v[94:95], v[94:95], v[158:159], v[174:175] op_sel_hi:[1,0,1]
    v_pk_fma_f32 v[100:101], v[100:101], v[158:159], v[176:177] op_sel_hi:[1,0,1]
    v_pk_fma_f32 v[102:103], v[102:103], v[158:159], v[178:179] op_sel_hi:[1,0,1]
    v_pk_mul_f32 v[236:237], v[92:93], v[92:93]
    v_pk_mul_f32 v[238:239], v[94:95], v[94:95]
    v_pk_mul_f32 v[240:241], v[100:101], v[100:101]
    v_pk_mul_f32 v[242:243], v[102:103], v[102:103]
    v_pk_fma_f32 v[236:237], v[236:237], v[220:221], v[222:223] op_sel_hi:[1,0,0]
    v_pk_fma_f32 v[238:239], v[238:239], v[220:221], v[222:223] op_sel_hi:[1,0,0]
    v_pk_fma_f32 v[240:241], v[240:241], v[220:221], v[222:223] op_sel_hi:[1,0,0]
    v_pk_fma_f32 v[242:243], v[242:243], v[220:221], v[222:223] op_sel_hi:[1,0,0]
    v_pk_mul_f32 v[236:237], v[236:237], v[92:93]
    v_pk_mul_f32 v[238:239], v[238:239], v[94:95]
    v_pk_mul_f32 v[240:241], v[240:241], v[100:101]
    v_pk_mul_f32 v[242:243], v[242:243], v[102:103]
    v_exp_f32 v236, v236
    v_exp_f32 v238, v238
    v_exp_f32 v240, v240
    v_exp_f32 v242, v242
    v_exp_f32 v237, v237
    v_exp_f32 v239, v239
    v_exp_f32 v241, v241
    v_exp_f32 v243, v243
    v_pk_add_f32 v[236:237], v[236:237], v[224:225] op_sel_hi:[1,0]
    v_pk_add_f32 v[238:239], v[238:239], v[224:225] op_sel_hi:[1,0]
    v_pk_add_f32 v[240:241], v[240:241], v[224:225] op_sel_hi:[1,0]
    v_pk_add_f32 v[242:243], v[242:243], v[224:225] op_sel_hi:[1,0]
    v_rcp_f32 v236, v236
    v_rcp_f32 v238, v238
    v_rcp_f32 v240, v240
    v_rcp_f32 v242, v242
    v_rcp_f32 v237, v237
    v_rcp_f32 v239, v239
    v_rcp_f32 v241, v241
    v_rcp_f32 v243, v243
    v_pk_mul_f32 v[236:237], v[236:237], v[92:93]
    v_pk_mul_f32 v[238:239], v[238:239], v[94:95]
    v_pk_mul_f32 v[240:241], v[240:241], v[100:101]
    v_pk_mul_f32 v[242:243], v[242:243], v[102:103]
    v_cvt_pk_bf16_f32 v196, v236, v237
    v_cvt_pk_bf16_f32 v197, v238, v239
    v_cvt_pk_bf16_f32 v198, v240, v241
    v_cvt_pk_bf16_f32 v199, v242, v243
    s_nop 0
    v_permlane16_swap_b32 v196, v198
    v_permlane16_swap_b32 v197, v199
    buffer_store_dwordx4 v[196:199], v217, s[44:47], s59 offen sc1
    v_pk_fma_f32 v[108:109], v[60:61], v[156:157], v[108:109] op_sel_hi:[1,0,1]
    v_pk_fma_f32 v[110:111], v[62:63], v[156:157], v[110:111] op_sel_hi:[1,0,1]
    v_pk_fma_f32 v[116:117], v[64:65], v[156:157], v[116:117] op_sel_hi:[1,0,1]
    v_pk_fma_f32 v[118:119], v[66:67], v[156:157], v[118:119] op_sel_hi:[1,0,1]
    v_pk_fma_f32 v[108:109], v[108:109], v[158:159], v[180:181] op_sel_hi:[1,0,1]
    v_pk_fma_f32 v[110:111], v[110:111], v[158:159], v[182:183] op_sel_hi:[1,0,1]
    v_pk_fma_f32 v[116:117], v[116:117], v[158:159], v[184:185] op_sel_hi:[1,0,1]
    v_pk_fma_f32 v[118:119], v[118:119], v[158:159], v[186:187] op_sel_hi:[1,0,1]
    v_pk_mul_f32 v[236:237], v[108:109], v[108:109]
    v_pk_mul_f32 v[238:239], v[110:111], v[110:111]
    v_pk_mul_f32 v[240:241], v[116:117], v[116:117]
    v_pk_mul_f32 v[242:243], v[118:119], v[118:119]
    v_pk_fma_f32 v[236:237], v[236:237], v[220:221], v[222:223] op_sel_hi:[1,0,0]
    v_pk_fma_f32 v[238:239], v[238:239], v[220:221], v[222:223] op_sel_hi:[1,0,0]
    v_pk_fma_f32 v[240:241], v[240:241], v[220:221], v[222:223] op_sel_hi:[1,0,0]
    v_pk_fma_f32 v[242:243], v[242:243], v[220:221], v[222:223] op_sel_hi:[1,0,0]
    v_pk_mul_f32 v[236:237], v[236:237], v[108:109]
    v_pk_mul_f32 v[238:239], v[238:239], v[110:111]
    v_pk_mul_f32 v[240:241], v[240:241], v[116:117]
    v_pk_mul_f32 v[242:243], v[242:243], v[118:119]
    v_exp_f32 v236, v236
    v_exp_f32 v238, v238
    v_exp_f32 v240, v240
    v_exp_f32 v242, v242
    v_exp_f32 v237, v237
    v_exp_f32 v239, v239
    v_exp_f32 v241, v241
    v_exp_f32 v243, v243
    v_pk_add_f32 v[236:237], v[236:237], v[224:225] op_sel_hi:[1,0]
    v_pk_add_f32 v[238:239], v[238:239], v[224:225] op_sel_hi:[1,0]
    v_pk_add_f32 v[240:241], v[240:241], v[224:225] op_sel_hi:[1,0]
    v_pk_add_f32 v[242:243], v[242:243], v[224:225] op_sel_hi:[1,0]
    v_rcp_f32 v236, v236
    v_rcp_f32 v238, v238
    v_rcp_f32 v240, v240
    v_rcp_f32 v242, v242
    v_rcp_f32 v237, v237
    v_rcp_f32 v239, v239
    v_rcp_f32 v241, v241
    v_rcp_f32 v243, v243
    v_pk_mul_f32 v[236:237], v[236:237], v[108:109]
    v_pk_mul_f32 v[238:239], v[238:239], v[110:111]
    v_pk_mul_f32 v[240:241], v[240:241], v[116:117]
    v_pk_mul_f32 v[242:243], v[242:243], v[118:119]
    v_cvt_pk_bf16_f32 v200, v236, v237
    v_cvt_pk_bf16_f32 v201, v238, v239
    v_cvt_pk_bf16_f32 v202, v240, v241
    v_cvt_pk_bf16_f32 v203, v242, v243
    s_nop 0
    v_permlane16_swap_b32 v200, v202
    v_permlane16_swap_b32 v201, v203
    buffer_store_dwordx4 v[200:203], v218, s[44:47], s59 offen sc1
    ds_read_b32 v237, v2 offset:80
    s_mov_b32 s36, s84
    s_mov_b32 s37, s85
    s_mov_b32 s38, 1835008
    s_mov_b32 s39, 0x00020000
    s_mov_b32 s40, s4
    s_mov_b32 s41, s5
    s_mov_b32 s42, 2097152
    s_mov_b32 s43, 0x00020000
    s_mov_b32 s64, s86
    s_mov_b32 s65, s87
    s_mov_b32 s66, 1024
    s_mov_b32 s67, 0x00020000
    s_mov_b32 s52, s88
    s_mov_b32 s53, s89
    s_mov_b32 s54, 2097152
    s_mov_b32 s55, 0x00020000
    s_add_u32 s60, s24, 20971520
    s_addc_u32 s61, s25, 0
    s_mov_b32 s62, 786432
    s_mov_b32 s63, 0x00020000
    v_lshlrev_b32 v236, 4, v1
    s_add_u32 s49, s3, 0
    s_and_b32 s49, s49, 3
    s_mul_i32 s49, s49, 57344
    v_add_u32 v4, s49, v236
    s_add_u32 s49, s3, 1
    s_and_b32 s49, s49, 3
    s_mul_i32 s49, s49, 57344
    v_add_u32 v5, s49, v236
    s_add_u32 s49, s3, 2
    s_and_b32 s49, s49, 3
    s_mul_i32 s49, s49, 57344
    v_add_u32 v6, s49, v236
    s_add_u32 s49, s3, 3
    s_and_b32 s49, s49, 3
    s_mul_i32 s49, s49, 57344
    v_add_u32 v7, s49, v236
    s_mul_i32 s48, s80, 229376
    s_lshl_b32 s49, s3, 10
    s_add_u32 s48, s48, s49
    v_lshrrev_b32 v12, 3, v1
    v_and_b32 v13, 7, v1
    v_bfe_u32 v14, v1, 4, 1
    v_lshlrev_b32 v14, 1, v14
    v_xor_b32 v13, v13, v14
    v_lshlrev_b32 v12, 10, v12
    s_lshl_b32 s49, s81, 7
    v_add_u32 v12, s49, v12
    v_xor_b32 v14, 0, v13
    v_lshl_add_u32 v8, v14, 4, v12
    v_xor_b32 v14, 4, v13
    v_lshl_add_u32 v9, v14, 4, v12
    v_add_u32 v9, 7168, v9
    v_xor_b32 v14, 0, v13
    v_lshl_add_u32 v10, v14, 4, v12
    v_add_u32 v10, 14336, v10
    v_xor_b32 v14, 4, v13
    v_lshl_add_u32 v11, v14, 4, v12
    v_add_u32 v11, 21504, v11
    s_lshl_b32 s50, s3, 15
    v_bfe_u32 v16, v1, 2, 2
    v_lshrrev_b32 v17, 1, v16
    v_and_b32 v18, 1, v3
    v_lshl_or_b32 v17, v18, 1, v17
    v_lshl_add_u32 v18, v3, 3, v16
    v_lshlrev_b32 v18, 7, v18
    v_and_b32 v20, 3, v1
    v_lshl_add_u32 v18, v20, 3, v18
    v_add_u32 v18, s50, v18
    v_xor_b32 v20, 0, v17
    v_lshl_add_u32 v12, v20, 5, v18
    v_xor_b32 v20, 1, v17
    v_lshl_add_u32 v13, v20, 5, v18
    v_xor_b32 v20, 2, v17
    v_lshl_add_u32 v14, v20, 5, v18
    v_xor_b32 v20, 3, v17
    v_lshl_add_u32 v15, v20, 5, v18
    s_lshl_b32 s49, s80, 6
    s_lshl_b32 s56, s3, 4
    s_add_u32 s49, s49, s56
    v_add_u32 v16, s49, v19
    v_lshlrev_b32 v16, 10, v16
    v_and_b32 v17, 1, v3
    v_lshl_add_u32 v16, v17, 5, v16
    v_lshrrev_b32 v17, 1, v3
    v_lshl_add_u32 v16, v17, 4, v16
    s_lshl_b32 s49, s81, 7
    v_add_u32 v16, s49, v16
    v_lshlrev_b32 v17, 3, v3
    v_mov_b32 v44, 1
    v_mov_b32 v45, v35
    v_mov_b32 v46, v2
    v_add_u32 v47, s50, v236
    v_bfe_u32 v18, v1, 2, 2
    v_lshl_add_u32 v18, v3, 2, v18
    v_bfe_u32 v20, v18, 1, 2
    v_xor_b32 v20, s3, v20
    v_lshlrev_b32 v18, 7, v18
    v_lshl_add_u32 v18, v20, 5, v18
    v_and_b32 v20, 3, v1
    v_lshl_add_u32 v18, v20, 3, v18
    v_add_u32 v18, 131072, v18
    s_add_u32 s56, s3, 1
    s_and_b32 s56, s56, 3
    s_lshl_b32 s56, s56, 15
    s_add_u32 s56, s56, 12288
    v_add_u32 v248, s56, v236
    s_add_u32 s56, s3, 2
    s_and_b32 s56, s56, 3
    s_lshl_b32 s56, s56, 15
    s_add_u32 s56, s56, 8192
    v_add_u32 v249, s56, v236
    s_add_u32 s56, s3, 3
    s_and_b32 s56, s56, 3
    s_lshl_b32 s56, s56, 15
    s_add_u32 s56, s56, 4096
    v_add_u32 v250, s56, v236
    s_lshl_b32 s56, s82, 1
    s_lshr_b32 s57, s3, 1
    s_add_u32 s56, s56, s57
    s_lshl_b32 s56, s56, 10
    s_lshl_b32 s57, s83, 3
    s_add_u32 s56, s56, s57
    s_and_b32 s57, s3, 1
    s_lshl_b32 s57, s57, 2
    s_add_u32 s56, s56, s57
    v_lshlrev_b32 v238, 7, v1
    v_and_b32 v239, 31, v1
    v_lshlrev_b32 v239, 2, v239
sp_29:
    ds_read_b32 v237, v46 offset:80
    s_waitcnt lgkmcnt(0)
    v_cmp_ne_u32 vcc, 0, v237
    s_cbranch_vccnz sp_29_d
    s_add_u32 s72, s72, 1
    s_cmp_lt_u32 s72, 0x80000
    s_cbranch_scc1 sp_29
sp_29_d:
    s_waitcnt vmcnt(0)
    s_mov_b64 exec, 0xff
    buffer_store_dword v237, v238, s[60:63], s56 offen sc1
    s_mov_b64 exec, -1
    buffer_load_dwordx4 v[20:23], v16, s[40:43], 0 offen
    buffer_load_dwordx4 v[24:27], v16, s[40:43], 0 offen offset:64
    buffer_load_dwordx2 v[240:241], v17, s[64:67], s49 offen offset:0
    buffer_load_dwordx2 v[242:243], v17, s[64:67], s49 offen offset:32
    buffer_load_dwordx2 v[244:245], v17, s[64:67], s49 offen offset:64
    buffer_load_dwordx2 v[246:247], v17, s[64:67], s49 offen offset:96
    s_setprio 1
sp_30:
    ds_read_b32 v28, v45 offset:64
    s_waitcnt lgkmcnt(0)
    v_cmp_eq_u32 vcc, 1, v28
    s_cbranch_vccnz sp_30_d
    s_sleep 1
    s_add_u32 s72, s72, 1
    s_cmp_lt_u32 s72, 0x80000
    s_cbranch_scc1 sp_30
sp_30_d:
    ds_read_b64_tr_b16 v[112:113], v12 offset:0
    ds_read_b64_tr_b16 v[114:115], v12 offset:512
    ds_read_b64_tr_b16 v[116:117], v13 offset:0
    ds_read_b64_tr_b16 v[118:119], v13 offset:512
    ds_read_b64_tr_b16 v[120:121], v14 offset:0
    ds_read_b64_tr_b16 v[122:123], v14 offset:512
    ds_read_b64_tr_b16 v[124:125], v15 offset:0
    ds_read_b64_tr_b16 v[126:127], v15 offset:512
    ds_read_b64_tr_b16 v[128:129], v12 offset:4096
    ds_read_b64_tr_b16 v[130:131], v12 offset:4608
    ds_read_b64_tr_b16 v[132:133], v13 offset:4096
    ds_read_b64_tr_b16 v[134:135], v13 offset:4608
    ds_read_b64_tr_b16 v[136:137], v14 offset:4096
    ds_read_b64_tr_b16 v[138:139], v14 offset:4608
    ds_read_b64_tr_b16 v[140:141], v15 offset:4096
    ds_read_b64_tr_b16 v[142:143], v15 offset:4608
    s_waitcnt lgkmcnt(8)
    s_add_u32 s59, s78, 7
    s_sub_u32 s77, s59, 14
    s_cmp_ge_u32 s59, 14
    s_cselect_b32 s59, s77, s59
    s_lshl_b32 s59, s59, 17
    s_add_u32 s59, s59, s50
    s_add_u32 m0, s50, 0
    s_nop 0
    buffer_load_dwordx4 v8, s[36:39], s59 offen lds
    buffer_load_dwordx4 v9, s[36:39], s59 offen offset:1024 lds
    buffer_load_dwordx4 v10, s[36:39], s59 offen offset:2048 lds
    buffer_load_dwordx4 v11, s[36:39], s59 offen offset:3072 lds
    ds_read_b64_tr_b16 v[144:145], v12 offset:8192
    ds_read_b64_tr_b16 v[146:147], v12 offset:8704
    ds_read_b64_tr_b16 v[148:149], v13 offset:8192
    ds_read_b64_tr_b16 v[150:151], v13 offset:8704
    ds_read_b64_tr_b16 v[152:153], v14 offset:8192
    ds_read_b64_tr_b16 v[154:155], v14 offset:8704
    ds_read_b64_tr_b16 v[156:157], v15 offset:8192
    ds_read_b64_tr_b16 v[158:159], v15 offset:8704
    s_waitcnt lgkmcnt(8)
    s_add_u32 s59, s78, 8
    s_sub_u32 s77, s59, 14
    s_cmp_ge_u32 s59, 14
    s_cselect_b32 s59, s77, s59
    s_lshl_b32 s59, s59, 17
    s_add_u32 s59, s59, s50
    s_add_u32 m0, s50, 4096
    s_nop 0
    buffer_load_dwordx4 v8, s[36:39], s59 offen lds
    buffer_load_dwordx4 v9, s[36:39], s59 offen offset:1024 lds
    buffer_load_dwordx4 v10, s[36:39], s59 offen offset:2048 lds
    buffer_load_dwordx4 v11, s[36:39], s59 offen offset:3072 lds
    ds_read_b64_tr_b16 v[28:29], v12 offset:12288
    ds_read_b64_tr_b16 v[30:31], v12 offset:12800
    ds_read_b64_tr_b16 v[32:33], v13 offset:12288
    ds_read_b64_tr_b16 v[34:35], v13 offset:12800
    ds_read_b64_tr_b16 v[36:37], v14 offset:12288
    ds_read_b64_tr_b16 v[38:39], v14 offset:12800
    ds_read_b64_tr_b16 v[40:41], v15 offset:12288
    ds_read_b64_tr_b16 v[42:43], v15 offset:12800
    s_waitcnt lgkmcnt(8)
    s_add_u32 s59, s78, 9
    s_sub_u32 s77, s59, 14
    s_cmp_ge_u32 s59, 14
    s_cselect_b32 s59, s77, s59
    s_lshl_b32 s59, s59, 17
    s_add_u32 s59, s59, s50
    s_add_u32 m0, s50, 8192
    s_nop 0
    buffer_load_dwordx4 v8, s[36:39], s59 offen lds
    buffer_load_dwordx4 v9, s[36:39], s59 offen offset:1024 lds
    buffer_load_dwordx4 v10, s[36:39], s59 offen offset:2048 lds
    buffer_load_dwordx4 v11, s[36:39], s59 offen offset:3072 lds
    s_waitcnt lgkmcnt(0)
    s_add_u32 s59, s78, 10
    s_sub_u32 s77, s59, 14
    s_cmp_ge_u32 s59, 14
    s_cselect_b32 s59, s77, s59
    s_lshl_b32 s59, s59, 17
    s_add_u32 s59, s59, s50
    s_add_u32 m0, s50, 12288
    s_nop 0
    buffer_load_dwordx4 v8, s[36:39], s59 offen lds
    buffer_load_dwordx4 v9, s[36:39], s59 offen offset:1024 lds
    buffer_load_dwordx4 v10, s[36:39], s59 offen offset:2048 lds
    buffer_load_dwordx4 v11, s[36:39], s59 offen offset:3072 lds
    s_lshl_b32 s56, s80, 10
    s_lshl_b32 s57, s81, 7
    s_add_u32 s56, s56, s57
    s_cmp_lg_u32 s3, 0
    s_cbranch_scc1 K_g1
    s_mov_b32 s79, 0
gp_31:
    buffer_load_dword v238, v239, s[60:63], s56 offen sc1
    s_waitcnt vmcnt(0)
    v_cmp_ne_u32 vcc, v237, v238
    s_cbranch_vccz gp_31_d
    s_sleep 4
    s_add_u32 s79, s79, 1
    s_cmp_lt_u32 s79, 0x4000
    s_cbranch_scc1 gp_31
gp_31_d:
    ds_write_b32 v46, v44 offset:100
K_g1:
sp_32:
    ds_read_b32 v238, v46 offset:100
    s_waitcnt lgkmcnt(0)
    v_cmp_eq_u32 vcc, 1, v238
    s_cbranch_vccnz sp_32_d
    s_sleep 1
    s_add_u32 s72, s72, 1
    s_cmp_lt_u32 s72, 0x80000
    s_cbranch_scc1 sp_32
sp_32_d:
    s_add_u32 s58, s78, 0
    s_sub_u32 s77, s58, 14
    s_cmp_ge_u32 s58, 14
    s_cselect_b32 s58, s77, s58
    s_lshl_b32 s58, s58, 12
    s_add_u32 s58, s58, s48
    buffer_load_dwordx4 v[160:163], v4, s[44:47], s58 offen sc1
    buffer_load_dwordx4 v[164:167], v5, s[44:47], s58 offen sc1
    buffer_load_dwordx4 v[168:171], v6, s[44:47], s58 offen sc1
    buffer_load_dwordx4 v[172:175], v7, s[44:47], s58 offen sc1
    s_add_u32 s58, s78, 1
    s_sub_u32 s77, s58, 14
    s_cmp_ge_u32 s58, 14
    s_cselect_b32 s58, s77, s58
    s_lshl_b32 s58, s58, 12
    s_add_u32 s58, s58, s48
    buffer_load_dwordx4 v[176:179], v4, s[44:47], s58 offen sc1
    buffer_load_dwordx4 v[180:183], v5, s[44:47], s58 offen sc1
    buffer_load_dwordx4 v[184:187], v6, s[44:47], s58 offen sc1
    buffer_load_dwordx4 v[188:191], v7, s[44:47], s58 offen sc1
    s_add_u32 s58, s78, 2
    s_sub_u32 s77, s58, 14
    s_cmp_ge_u32 s58, 14
    s_cselect_b32 s58, s77, s58
    s_lshl_b32 s58, s58, 12
    s_add_u32 s58, s58, s48
    buffer_load_dwordx4 v[192:195], v4, s[44:47], s58 offen sc1
    buffer_load_dwordx4 v[196:199], v5, s[44:47], s58 offen sc1
    buffer_load_dwordx4 v[200:203], v6, s[44:47], s58 offen sc1
    buffer_load_dwordx4 v[204:207], v7, s[44:47], s58 offen sc1
    s_waitcnt vmcnt(8)
    s_add_u32 s58, s78, 3
    s_sub_u32 s77, s58, 14
    s_cmp_ge_u32 s58, 14
    s_cselect_b32 s58, s77, s58
    s_lshl_b32 s58, s58, 12
    s_add_u32 s58, s58, s48
    buffer_load_dwordx4 v[208:211], v4, s[44:47], s58 offen sc1
    buffer_load_dwordx4 v[212:215], v5, s[44:47], s58 offen sc1
    buffer_load_dwordx4 v[216:219], v6, s[44:47], s58 offen sc1
    buffer_load_dwordx4 v[220:223], v7, s[44:47], s58 offen sc1
    v_mfma_f32_16x16x32_bf16 v[48:51], v[112:115], v[160:163], 0
    v_mfma_f32_16x16x32_bf16 v[64:67], v[112:115], v[164:167], 0
    v_mfma_f32_16x16x32_bf16 v[80:83], v[112:115], v[168:171], 0
    v_mfma_f32_16x16x32_bf16 v[96:99], v[112:115], v[172:175], 0
    v_mfma_f32_16x16x32_bf16 v[52:55], v[116:119], v[160:163], 0
    v_mfma_f32_16x16x32_bf16 v[68:71], v[116:119], v[164:167], 0
    v_mfma_f32_16x16x32_bf16 v[84:87], v[116:119], v[168:171], 0
    v_mfma_f32_16x16x32_bf16 v[100:103], v[116:119], v[172:175], 0
    v_mfma_f32_16x16x32_bf16 v[56:59], v[120:123], v[160:163], 0
    v_mfma_f32_16x16x32_bf16 v[72:75], v[120:123], v[164:167], 0
    v_mfma_f32_16x16x32_bf16 v[88:91], v[120:123], v[168:171], 0
    v_mfma_f32_16x16x32_bf16 v[104:107], v[120:123], v[172:175], 0
    v_mfma_f32_16x16x32_bf16 v[60:63], v[124:127], v[160:163], 0
    v_mfma_f32_16x16x32_bf16 v[76:79], v[124:127], v[164:167], 0
    v_mfma_f32_16x16x32_bf16 v[92:95], v[124:127], v[168:171], 0
    v_mfma_f32_16x16x32_bf16 v[108:111], v[124:127], v[172:175], 0
    s_waitcnt vmcnt(8)
    s_add_u32 s58, s78, 4
    s_sub_u32 s77, s58, 14
    s_cmp_ge_u32 s58, 14
    s_cselect_b32 s58, s77, s58
    s_lshl_b32 s58, s58, 12
    s_add_u32 s58, s58, s48
    buffer_load_dwordx4 v[160:163], v4, s[44:47], s58 offen sc1
    buffer_load_dwordx4 v[164:167], v5, s[44:47], s58 offen sc1
    buffer_load_dwordx4 v[168:171], v6, s[44:47], s58 offen sc1
    buffer_load_dwordx4 v[172:175], v7, s[44:47], s58 offen sc1
    v_mfma_f32_16x16x32_bf16 v[48:51], v[128:131], v[176:179], v[48:51]
    v_mfma_f32_16x16x32_bf16 v[64:67], v[128:131], v[180:183], v[64:67]
    v_mfma_f32_16x16x32_bf16 v[80:83], v[128:131], v[184:187], v[80:83]
    v_mfma_f32_16x16x32_bf16 v[96:99], v[128:131], v[188:191], v[96:99]
    v_mfma_f32_16x16x32_bf16 v[52:55], v[132:135], v[176:179], v[52:55]
    v_mfma_f32_16x16x32_bf16 v[68:71], v[132:135], v[180:183], v[68:71]
    v_mfma_f32_16x16x32_bf16 v[84:87], v[132:135], v[184:187], v[84:87]
    v_mfma_f32_16x16x32_bf16 v[100:103], v[132:135], v[188:191], v[100:103]
    v_mfma_f32_16x16x32_bf16 v[56:59], v[136:139], v[176:179], v[56:59]
    v_mfma_f32_16x16x32_bf16 v[72:75], v[136:139], v[180:183], v[72:75]
    v_mfma_f32_16x16x32_bf16 v[88:91], v[136:139], v[184:187], v[88:91]
    v_mfma_f32_16x16x32_bf16 v[104:107], v[136:139], v[188:191], v[104:107]
    v_mfma_f32_16x16x32_bf16 v[60:63], v[140:143], v[176:179], v[60:63]
    v_mfma_f32_16x16x32_bf16 v[76:79], v[140:143], v[180:183], v[76:79]
    v_mfma_f32_16x16x32_bf16 v[92:95], v[140:143], v[184:187], v[92:95]
    v_mfma_f32_16x16x32_bf16 v[108:111], v[140:143], v[188:191], v[108:111]
    s_waitcnt vmcnt(8)
    s_add_u32 s58, s78, 5
    s_sub_u32 s77, s58, 14
    s_cmp_ge_u32 s58, 14
    s_cselect_b32 s58, s77, s58
    s_lshl_b32 s58, s58, 12
    s_add_u32 s58, s58, s48
    buffer_load_dwordx4 v[176:179], v4, s[44:47], s58 offen sc1
    buffer_load_dwordx4 v[180:183], v5, s[44:47], s58 offen sc1
    buffer_load_dwordx4 v[184:187], v6, s[44:47], s58 offen sc1
    buffer_load_dwordx4 v[188:191], v7, s[44:47], s58 offen sc1
    v_mfma_f32_16x16x32_bf16 v[48:51], v[144:147], v[192:195], v[48:51]
    v_mfma_f32_16x16x32_bf16 v[64:67], v[144:147], v[196:199], v[64:67]
    v_mfma_f32_16x16x32_bf16 v[80:83], v[144:147], v[200:203], v[80:83]
    v_mfma_f32_16x16x32_bf16 v[96:99], v[144:147], v[204:207], v[96:99]
    v_mfma_f32_16x16x32_bf16 v[52:55], v[148:151], v[192:195], v[52:55]
    v_mfma_f32_16x16x32_bf16 v[68:71], v[148:151], v[196:199], v[68:71]
    v_mfma_f32_16x16x32_bf16 v[84:87], v[148:151], v[200:203], v[84:87]
    v_mfma_f32_16x16x32_bf16 v[100:103], v[148:151], v[204:207], v[100:103]
    v_mfma_f32_16x16x32_bf16 v[56:59], v[152:155], v[192:195], v[56:59]
    v_mfma_f32_16x16x32_bf16 v[72:75], v[152:155], v[196:199], v[72:75]
    v_mfma_f32_16x16x32_bf16 v[88:91], v[152:155], v[200:203], v[88:91]
    v_mfma_f32_16x16x32_bf16 v[104:107], v[152:155], v[204:207], v[104:107]
    v_mfma_f32_16x16x32_bf16 v[60:63], v[156:159], v[192:195], v[60:63]
    v_mfma_f32_16x16x32_bf16 v[76:79], v[156:159], v[196:199], v[76:79]
    v_mfma_f32_16x16x32_bf16 v[92:95], v[156:159], v[200:203], v[92:95]
    v_mfma_f32_16x16x32_bf16 v[108:111], v[156:159], v[204:207], v[108:111]
    s_waitcnt vmcnt(8)
    s_add_u32 s58, s78, 6
    s_sub_u32 s77, s58, 14
    s_cmp_ge_u32 s58, 14
    s_cselect_b32 s58, s77, s58
    s_lshl_b32 s58, s58, 12
    s_add_u32 s58, s58, s48
    buffer_load_dwordx4 v[192:195], v4, s[44:47], s58 offen sc1
    buffer_load_dwordx4 v[196:199], v5, s[44:47], s58 offen sc1
    buffer_load_dwordx4 v[200:203], v6, s[44:47], s58 offen sc1
    buffer_load_dwordx4 v[204:207], v7, s[44:47], s58 offen sc1
    v_mfma_f32_16x16x32_bf16 v[48:51], v[28:31], v[208:211], v[48:51]
    v_mfma_f32_16x16x32_bf16 v[64:67], v[28:31], v[212:215], v[64:67]
    v_mfma_f32_16x16x32_bf16 v[80:83], v[28:31], v[216:219], v[80:83]
    v_mfma_f32_16x16x32_bf16 v[96:99], v[28:31], v[220:223], v[96:99]
    ds_read_b64_tr_b16 v[28:29], v12 offset:16384
    ds_read_b64_tr_b16 v[30:31], v12 offset:16896
    v_mfma_f32_16x16x32_bf16 v[52:55], v[32:35], v[208:211], v[52:55]
    v_mfma_f32_16x16x32_bf16 v[68:71], v[32:35], v[212:215], v[68:71]
    v_mfma_f32_16x16x32_bf16 v[84:87], v[32:35], v[216:219], v[84:87]
    v_mfma_f32_16x16x32_bf16 v[100:103], v[32:35], v[220:223], v[100:103]
    ds_read_b64_tr_b16 v[32:33], v13 offset:16384
    ds_read_b64_tr_b16 v[34:35], v13 offset:16896
    v_mfma_f32_16x16x32_bf16 v[56:59], v[36:39], v[208:211], v[56:59]
    v_mfma_f32_16x16x32_bf16 v[72:75], v[36:39], v[212:215], v[72:75]
    v_mfma_f32_16x16x32_bf16 v[88:91], v[36:39], v[216:219], v[88:91]
    v_mfma_f32_16x16x32_bf16 v[104:107], v[36:39], v[220:223], v[104:107]
    ds_read_b64_tr_b16 v[36:37], v14 offset:16384
    ds_read_b64_tr_b16 v[38:39], v14 offset:16896
    v_mfma_f32_16x16x32_bf16 v[60:63], v[40:43], v[208:211], v[60:63]
    v_mfma_f32_16x16x32_bf16 v[76:79], v[40:43], v[212:215], v[76:79]
    v_mfma_f32_16x16x32_bf16 v[92:95], v[40:43], v[216:219], v[92:95]
    v_mfma_f32_16x16x32_bf16 v[108:111], v[40:43], v[220:223], v[108:111]
    ds_read_b64_tr_b16 v[40:41], v15 offset:16384
    ds_read_b64_tr_b16 v[42:43], v15 offset:16896
    s_waitcnt vmcnt(8)
    s_add_u32 s58, s78, 7
    s_sub_u32 s77, s58, 14
    s_cmp_ge_u32 s58, 14
    s_cselect_b32 s58, s77, s58
    s_lshl_b32 s58, s58, 12
    s_add_u32 s58, s58, s48
    buffer_load_dwordx4 v[208:211], v4, s[44:47], s58 offen sc1
    buffer_load_dwordx4 v[212:215], v5, s[44:47], s58 offen sc1
    buffer_load_dwordx4 v[216:219], v6, s[44:47], s58 offen sc1
    buffer_load_dwordx4 v[220:223], v7, s[44:47], s58 offen sc1
    s_waitcnt lgkmcnt(6)
    v_mfma_f32_16x16x32_bf16 v[48:51], v[28:31], v[160:163], v[48:51]
    v_mfma_f32_16x16x32_bf16 v[64:67], v[28:31], v[164:167], v[64:67]
    v_mfma_f32_16x16x32_bf16 v[80:83], v[28:31], v[168:171], v[80:83]
    v_mfma_f32_16x16x32_bf16 v[96:99], v[28:31], v[172:175], v[96:99]
    ds_read_b64_tr_b16 v[28:29], v12 offset:20480
    ds_read_b64_tr_b16 v[30:31], v12 offset:20992
    s_waitcnt lgkmcnt(6)
    v_mfma_f32_16x16x32_bf16 v[52:55], v[32:35], v[160:163], v[52:55]
    v_mfma_f32_16x16x32_bf16 v[68:71], v[32:35], v[164:167], v[68:71]
    v_mfma_f32_16x16x32_bf16 v[84:87], v[32:35], v[168:171], v[84:87]
    v_mfma_f32_16x16x32_bf16 v[100:103], v[32:35], v[172:175], v[100:103]
    ds_read_b64_tr_b16 v[32:33], v13 offset:20480
    ds_read_b64_tr_b16 v[34:35], v13 offset:20992
    s_waitcnt lgkmcnt(6)
    v_mfma_f32_16x16x32_bf16 v[56:59], v[36:39], v[160:163], v[56:59]
    v_mfma_f32_16x16x32_bf16 v[72:75], v[36:39], v[164:167], v[72:75]
    v_mfma_f32_16x16x32_bf16 v[88:91], v[36:39], v[168:171], v[88:91]
    v_mfma_f32_16x16x32_bf16 v[104:107], v[36:39], v[172:175], v[104:107]
    ds_read_b64_tr_b16 v[36:37], v14 offset:20480
    ds_read_b64_tr_b16 v[38:39], v14 offset:20992
    s_waitcnt lgkmcnt(6)
    v_mfma_f32_16x16x32_bf16 v[60:63], v[40:43], v[160:163], v[60:63]
    v_mfma_f32_16x16x32_bf16 v[76:79], v[40:43], v[164:167], v[76:79]
    v_mfma_f32_16x16x32_bf16 v[92:95], v[40:43], v[168:171], v[92:95]
    v_mfma_f32_16x16x32_bf16 v[108:111], v[40:43], v[172:175], v[108:111]
    ds_read_b64_tr_b16 v[40:41], v15 offset:20480
    ds_read_b64_tr_b16 v[42:43], v15 offset:20992
    s_waitcnt vmcnt(8)
    s_add_u32 s58, s78, 8
    s_sub_u32 s77, s58, 14
    s_cmp_ge_u32 s58, 14
    s_cselect_b32 s58, s77, s58
    s_lshl_b32 s58, s58, 12
    s_add_u32 s58, s58, s48
    buffer_load_dwordx4 v[160:163], v4, s[44:47], s58 offen sc1
    buffer_load_dwordx4 v[164:167], v5, s[44:47], s58 offen sc1
    buffer_load_dwordx4 v[168:171], v6, s[44:47], s58 offen sc1
    buffer_load_dwordx4 v[172:175], v7, s[44:47], s58 offen sc1
    s_add_u32 s59, s78, 11
    s_sub_u32 s77, s59, 14
    s_cmp_ge_u32 s59, 14
    s_cselect_b32 s59, s77, s59
    s_lshl_b32 s59, s59, 17
    s_add_u32 s59, s59, s50
    s_add_u32 m0, s50, 16384
    s_nop 0
    buffer_load_dwordx4 v8, s[36:39], s59 offen lds
    buffer_load_dwordx4 v9, s[36:39], s59 offen offset:1024 lds
    buffer_load_dwordx4 v10, s[36:39], s59 offen offset:2048 lds
    buffer_load_dwordx4 v11, s[36:39], s59 offen offset:3072 lds
    s_waitcnt lgkmcnt(6)
    v_mfma_f32_16x16x32_bf16 v[48:51], v[28:31], v[176:179], v[48:51]
    v_mfma_f32_16x16x32_bf16 v[64:67], v[28:31], v[180:183], v[64:67]
    v_mfma_f32_16x16x32_bf16 v[80:83], v[28:31], v[184:187], v[80:83]
    v_mfma_f32_16x16x32_bf16 v[96:99], v[28:31], v[188:191], v[96:99]
    ds_read_b64_tr_b16 v[28:29], v12 offset:24576
    ds_read_b64_tr_b16 v[30:31], v12 offset:25088
    s_waitcnt lgkmcnt(6)
    v_mfma_f32_16x16x32_bf16 v[52:55], v[32:35], v[176:179], v[52:55]
    v_mfma_f32_16x16x32_bf16 v[68:71], v[32:35], v[180:183], v[68:71]
    v_mfma_f32_16x16x32_bf16 v[84:87], v[32:35], v[184:187], v[84:87]
    v_mfma_f32_16x16x32_bf16 v[100:103], v[32:35], v[188:191], v[100:103]
    ds_read_b64_tr_b16 v[32:33], v13 offset:24576
    ds_read_b64_tr_b16 v[34:35], v13 offset:25088
    s_waitcnt lgkmcnt(6)
    v_mfma_f32_16x16x32_bf16 v[56:59], v[36:39], v[176:179], v[56:59]
    v_mfma_f32_16x16x32_bf16 v[72:75], v[36:39], v[180:183], v[72:75]
    v_mfma_f32_16x16x32_bf16 v[88:91], v[36:39], v[184:187], v[88:91]
    v_mfma_f32_16x16x32_bf16 v[104:107], v[36:39], v[188:191], v[104:107]
    ds_read_b64_tr_b16 v[36:37], v14 offset:24576
    ds_read_b64_tr_b16 v[38:39], v14 offset:25088
    s_waitcnt lgkmcnt(6)
    v_mfma_f32_16x16x32_bf16 v[60:63], v[40:43], v[176:179], v[60:63]
    v_mfma_f32_16x16x32_bf16 v[76:79], v[40:43], v[180:183], v[76:79]
    v_mfma_f32_16x16x32_bf16 v[92:95], v[40:43], v[184:187], v[92:95]
    v_mfma_f32_16x16x32_bf16 v[108:111], v[40:43], v[188:191], v[108:111]
    ds_read_b64_tr_b16 v[40:41], v15 offset:24576
    ds_read_b64_tr_b16 v[42:43], v15 offset:25088
    s_waitcnt vmcnt(12)
    s_add_u32 s58, s78, 9
    s_sub_u32 s77, s58, 14
    s_cmp_ge_u32 s58, 14
    s_cselect_b32 s58, s77, s58
    s_lshl_b32 s58, s58, 12
    s_add_u32 s58, s58, s48
    buffer_load_dwordx4 v[176:179], v4, s[44:47], s58 offen sc1
    buffer_load_dwordx4 v[180:183], v5, s[44:47], s58 offen sc1
    buffer_load_dwordx4 v[184:187], v6, s[44:47], s58 offen sc1
    buffer_load_dwordx4 v[188:191], v7, s[44:47], s58 offen sc1
    s_add_u32 s59, s78, 12
    s_sub_u32 s77, s59, 14
    s_cmp_ge_u32 s59, 14
    s_cselect_b32 s59, s77, s59
    s_lshl_b32 s59, s59, 17
    s_add_u32 s59, s59, s50
    s_add_u32 m0, s50, 20480
    s_nop 0
    buffer_load_dwordx4 v8, s[36:39], s59 offen lds
    buffer_load_dwordx4 v9, s[36:39], s59 offen offset:1024 lds
    buffer_load_dwordx4 v10, s[36:39], s59 offen offset:2048 lds
    buffer_load_dwordx4 v11, s[36:39], s59 offen offset:3072 lds
    s_waitcnt lgkmcnt(6)
    v_mfma_f32_16x16x32_bf16 v[48:51], v[28:31], v[192:195], v[48:51]
    v_mfma_f32_16x16x32_bf16 v[64:67], v[28:31], v[196:199], v[64:67]
    v_mfma_f32_16x16x32_bf16 v[80:83], v[28:31], v[200:203], v[80:83]
    v_mfma_f32_16x16x32_bf16 v[96:99], v[28:31], v[204:207], v[96:99]
    ds_read_b64_tr_b16 v[28:29], v12 offset:0
    ds_read_b64_tr_b16 v[30:31], v12 offset:512
    s_waitcnt lgkmcnt(6)
    v_mfma_f32_16x16x32_bf16 v[52:55], v[32:35], v[192:195], v[52:55]
    v_mfma_f32_16x16x32_bf16 v[68:71], v[32:35], v[196:199], v[68:71]
    v_mfma_f32_16x16x32_bf16 v[84:87], v[32:35], v[200:203], v[84:87]
    v_mfma_f32_16x16x32_bf16 v[100:103], v[32:35], v[204:207], v[100:103]
    ds_read_b64_tr_b16 v[32:33], v13 offset:0
    ds_read_b64_tr_b16 v[34:35], v13 offset:512
    s_waitcnt lgkmcnt(6)
    v_mfma_f32_16x16x32_bf16 v[56:59], v[36:39], v[192:195], v[56:59]
    v_mfma_f32_16x16x32_bf16 v[72:75], v[36:39], v[196:199], v[72:75]
    v_mfma_f32_16x16x32_bf16 v[88:91], v[36:39], v[200:203], v[88:91]
    v_mfma_f32_16x16x32_bf16 v[104:107], v[36:39], v[204:207], v[104:107]
    ds_read_b64_tr_b16 v[36:37], v14 offset:0
    ds_read_b64_tr_b16 v[38:39], v14 offset:512
    s_waitcnt lgkmcnt(6)
    v_mfma_f32_16x16x32_bf16 v[60:63], v[40:43], v[192:195], v[60:63]
    v_mfma_f32_16x16x32_bf16 v[76:79], v[40:43], v[196:199], v[76:79]
    v_mfma_f32_16x16x32_bf16 v[92:95], v[40:43], v[200:203], v[92:95]
    v_mfma_f32_16x16x32_bf16 v[108:111], v[40:43], v[204:207], v[108:111]
    ds_read_b64_tr_b16 v[40:41], v15 offset:0
    ds_read_b64_tr_b16 v[42:43], v15 offset:512
    ds_write_b32 v45, v44 offset:176
    s_waitcnt vmcnt(16)
    s_add_u32 s58, s78, 10
    s_sub_u32 s77, s58, 14
    s_cmp_ge_u32 s58, 14
    s_cselect_b32 s58, s77, s58
    s_lshl_b32 s58, s58, 12
    s_add_u32 s58, s58, s48
    buffer_load_dwordx4 v[192:195], v4, s[44:47], s58 offen sc1
    buffer_load_dwordx4 v[196:199], v5, s[44:47], s58 offen sc1
    buffer_load_dwordx4 v[200:203], v6, s[44:47], s58 offen sc1
    buffer_load_dwordx4 v[204:207], v7, s[44:47], s58 offen sc1
    s_add_u32 s59, s78, 13
    s_sub_u32 s77, s59, 14
    s_cmp_ge_u32 s59, 14
    s_cselect_b32 s59, s77, s59
    s_lshl_b32 s59, s59, 17
    s_add_u32 s59, s59, s50
    s_add_u32 m0, s50, 24576
    s_nop 0
    buffer_load_dwordx4 v8, s[36:39], s59 offen lds
    buffer_load_dwordx4 v9, s[36:39], s59 offen offset:1024 lds
    buffer_load_dwordx4 v10, s[36:39], s59 offen offset:2048 lds
    buffer_load_dwordx4 v11, s[36:39], s59 offen offset:3072 lds
    s_waitcnt lgkmcnt(7)
    v_mfma_f32_16x16x32_bf16 v[48:51], v[28:31], v[208:211], v[48:51]
    v_mfma_f32_16x16x32_bf16 v[64:67], v[28:31], v[212:215], v[64:67]
    v_mfma_f32_16x16x32_bf16 v[80:83], v[28:31], v[216:219], v[80:83]
    v_mfma_f32_16x16x32_bf16 v[96:99], v[28:31], v[220:223], v[96:99]
    ds_read_b64_tr_b16 v[28:29], v12 offset:4096
    ds_read_b64_tr_b16 v[30:31], v12 offset:4608
    s_waitcnt lgkmcnt(7)
    v_mfma_f32_16x16x32_bf16 v[52:55], v[32:35], v[208:211], v[52:55]
    v_mfma_f32_16x16x32_bf16 v[68:71], v[32:35], v[212:215], v[68:71]
    v_mfma_f32_16x16x32_bf16 v[84:87], v[32:35], v[216:219], v[84:87]
    v_mfma_f32_16x16x32_bf16 v[100:103], v[32:35], v[220:223], v[100:103]
    ds_read_b64_tr_b16 v[32:33], v13 offset:4096
    ds_read_b64_tr_b16 v[34:35], v13 offset:4608
    s_waitcnt lgkmcnt(7)
    v_mfma_f32_16x16x32_bf16 v[56:59], v[36:39], v[208:211], v[56:59]
    v_mfma_f32_16x16x32_bf16 v[72:75], v[36:39], v[212:215], v[72:75]
    v_mfma_f32_16x16x32_bf16 v[88:91], v[36:39], v[216:219], v[88:91]
    v_mfma_f32_16x16x32_bf16 v[104:107], v[36:39], v[220:223], v[104:107]
    ds_read_b64_tr_b16 v[36:37], v14 offset:4096
    ds_read_b64_tr_b16 v[38:39], v14 offset:4608
    s_waitcnt lgkmcnt(7)
    v_mfma_f32_16x16x32_bf16 v[60:63], v[40:43], v[208:211], v[60:63]
    v_mfma_f32_16x16x32_bf16 v[76:79], v[40:43], v[212:215], v[76:79]
    v_mfma_f32_16x16x32_bf16 v[92:95], v[40:43], v[216:219], v[92:95]
    v_mfma_f32_16x16x32_bf16 v[108:111], v[40:43], v[220:223], v[108:111]
    ds_read_b64_tr_b16 v[40:41], v15 offset:4096
    ds_read_b64_tr_b16 v[42:43], v15 offset:4608
    s_waitcnt vmcnt(20)
    s_add_u32 s58, s78, 11
    s_sub_u32 s77, s58, 14
    s_cmp_ge_u32 s58, 14
    s_cselect_b32 s58, s77, s58
    s_lshl_b32 s58, s58, 12
    s_add_u32 s58, s58, s48
    buffer_load_dwordx4 v[208:211], v4, s[44:47], s58 offen sc1
    buffer_load_dwordx4 v[212:215], v5, s[44:47], s58 offen sc1
    buffer_load_dwordx4 v[216:219], v6, s[44:47], s58 offen sc1
    buffer_load_dwordx4 v[220:223], v7, s[44:47], s58 offen sc1
    s_waitcnt lgkmcnt(6)
    v_mfma_f32_16x16x32_bf16 v[48:51], v[28:31], v[160:163], v[48:51]
    v_mfma_f32_16x16x32_bf16 v[64:67], v[28:31], v[164:167], v[64:67]
    v_mfma_f32_16x16x32_bf16 v[80:83], v[28:31], v[168:171], v[80:83]
    v_mfma_f32_16x16x32_bf16 v[96:99], v[28:31], v[172:175], v[96:99]
    ds_read_b64_tr_b16 v[28:29], v12 offset:8192
    ds_read_b64_tr_b16 v[30:31], v12 offset:8704
    s_waitcnt lgkmcnt(6)
    v_mfma_f32_16x16x32_bf16 v[52:55], v[32:35], v[160:163], v[52:55]
    v_mfma_f32_16x16x32_bf16 v[68:71], v[32:35], v[164:167], v[68:71]
    v_mfma_f32_16x16x32_bf16 v[84:87], v[32:35], v[168:171], v[84:87]
    v_mfma_f32_16x16x32_bf16 v[100:103], v[32:35], v[172:175], v[100:103]
    ds_read_b64_tr_b16 v[32:33], v13 offset:8192
    ds_read_b64_tr_b16 v[34:35], v13 offset:8704
    s_waitcnt lgkmcnt(6)
    v_mfma_f32_16x16x32_bf16 v[56:59], v[36:39], v[160:163], v[56:59]
    v_mfma_f32_16x16x32_bf16 v[72:75], v[36:39], v[164:167], v[72:75]
    v_mfma_f32_16x16x32_bf16 v[88:91], v[36:39], v[168:171], v[88:91]
    v_mfma_f32_16x16x32_bf16 v[104:107], v[36:39], v[172:175], v[104:107]
    ds_read_b64_tr_b16 v[36:37], v14 offset:8192
    ds_read_b64_tr_b16 v[38:39], v14 offset:8704
    s_waitcnt lgkmcnt(6)
    v_mfma_f32_16x16x32_bf16 v[60:63], v[40:43], v[160:163], v[60:63]
    v_mfma_f32_16x16x32_bf16 v[76:79], v[40:43], v[164:167], v[76:79]
    v_mfma_f32_16x16x32_bf16 v[92:95], v[40:43], v[168:171], v[92:95]
    v_mfma_f32_16x16x32_bf16 v[108:111], v[40:43], v[172:175], v[108:111]
    ds_read_b64_tr_b16 v[40:41], v15 offset:8192
    ds_read_b64_tr_b16 v[42:43], v15 offset:8704
    s_waitcnt vmcnt(16)
    s_add_u32 s58, s78, 12
    s_sub_u32 s77, s58, 14
    s_cmp_ge_u32 s58, 14
    s_cselect_b32 s58, s77, s58
    s_lshl_b32 s58, s58, 12
    s_add_u32 s58, s58, s48
    buffer_load_dwordx4 v[160:163], v4, s[44:47], s58 offen sc1
    buffer_load_dwordx4 v[164:167], v5, s[44:47], s58 offen sc1
    buffer_load_dwordx4 v[168:171], v6, s[44:47], s58 offen sc1
    buffer_load_dwordx4 v[172:175], v7, s[44:47], s58 offen sc1
    s_waitcnt lgkmcnt(6)
    v_mfma_f32_16x16x32_bf16 v[48:51], v[28:31], v[176:179], v[48:51]
    v_mfma_f32_16x16x32_bf16 v[64:67], v[28:31], v[180:183], v[64:67]
    v_mfma_f32_16x16x32_bf16 v[80:83], v[28:31], v[184:187], v[80:83]
    v_mfma_f32_16x16x32_bf16 v[96:99], v[28:31], v[188:191], v[96:99]
    ds_read_b64_tr_b16 v[28:29], v12 offset:12288
    ds_read_b64_tr_b16 v[30:31], v12 offset:12800
    s_waitcnt lgkmcnt(6)
    v_mfma_f32_16x16x32_bf16 v[52:55], v[32:35], v[176:179], v[52:55]
    v_mfma_f32_16x16x32_bf16 v[68:71], v[32:35], v[180:183], v[68:71]
    v_mfma_f32_16x16x32_bf16 v[84:87], v[32:35], v[184:187], v[84:87]
    v_mfma_f32_16x16x32_bf16 v[100:103], v[32:35], v[188:191], v[100:103]
    ds_read_b64_tr_b16 v[32:33], v13 offset:12288
    ds_read_b64_tr_b16 v[34:35], v13 offset:12800
    s_waitcnt lgkmcnt(6)
    v_mfma_f32_16x16x32_bf16 v[56:59], v[36:39], v[176:179], v[56:59]
    v_mfma_f32_16x16x32_bf16 v[72:75], v[36:39], v[180:183], v[72:75]
    v_mfma_f32_16x16x32_bf16 v[88:91], v[36:39], v[184:187], v[88:91]
    v_mfma_f32_16x16x32_bf16 v[104:107], v[36:39], v[188:191], v[104:107]
    ds_read_b64_tr_b16 v[36:37], v14 offset:12288
    ds_read_b64_tr_b16 v[38:39], v14 offset:12800
    s_waitcnt lgkmcnt(6)
    v_mfma_f32_16x16x32_bf16 v[60:63], v[40:43], v[176:179], v[60:63]
    v_mfma_f32_16x16x32_bf16 v[76:79], v[40:43], v[180:183], v[76:79]
    v_mfma_f32_16x16x32_bf16 v[92:95], v[40:43], v[184:187], v[92:95]
    v_mfma_f32_16x16x32_bf16 v[108:111], v[40:43], v[188:191], v[108:111]
    ds_read_b64_tr_b16 v[40:41], v15 offset:12288
    ds_read_b64_tr_b16 v[42:43], v15 offset:12800
    s_waitcnt vmcnt(12)
    s_add_u32 s58, s78, 13
    s_sub_u32 s77, s58, 14
    s_cmp_ge_u32 s58, 14
    s_cselect_b32 s58, s77, s58
    s_lshl_b32 s58, s58, 12
    s_add_u32 s58, s58, s48
    buffer_load_dwordx4 v[176:179], v4, s[44:47], s58 offen sc1
    buffer_load_dwordx4 v[180:183], v5, s[44:47], s58 offen sc1
    buffer_load_dwordx4 v[184:187], v6, s[44:47], s58 offen sc1
    buffer_load_dwordx4 v[188:191], v7, s[44:47], s58 offen sc1
    s_waitcnt lgkmcnt(6)
    v_mfma_f32_16x16x32_bf16 v[48:51], v[28:31], v[192:195], v[48:51]
    v_mfma_f32_16x16x32_bf16 v[64:67], v[28:31], v[196:199], v[64:67]
    v_mfma_f32_16x16x32_bf16 v[80:83], v[28:31], v[200:203], v[80:83]
    v_mfma_f32_16x16x32_bf16 v[96:99], v[28:31], v[204:207], v[96:99]
    ds_read_b64_tr_b16 v[28:29], v12 offset:16384
    ds_read_b64_tr_b16 v[30:31], v12 offset:16896
    s_waitcnt lgkmcnt(6)
    v_mfma_f32_16x16x32_bf16 v[52:55], v[32:35], v[192:195], v[52:55]
    v_mfma_f32_16x16x32_bf16 v[68:71], v[32:35], v[196:199], v[68:71]
    v_mfma_f32_16x16x32_bf16 v[84:87], v[32:35], v[200:203], v[84:87]
    v_mfma_f32_16x16x32_bf16 v[100:103], v[32:35], v[204:207], v[100:103]
    ds_read_b64_tr_b16 v[32:33], v13 offset:16384
    ds_read_b64_tr_b16 v[34:35], v13 offset:16896
    s_waitcnt lgkmcnt(6)
    v_mfma_f32_16x16x32_bf16 v[56:59], v[36:39], v[192:195], v[56:59]
    v_mfma_f32_16x16x32_bf16 v[72:75], v[36:39], v[196:199], v[72:75]
    v_mfma_f32_16x16x32_bf16 v[88:91], v[36:39], v[200:203], v[88:91]
    v_mfma_f32_16x16x32_bf16 v[104:107], v[36:39], v[204:207], v[104:107]
    ds_read_b64_tr_b16 v[36:37], v14 offset:16384
    ds_read_b64_tr_b16 v[38:39], v14 offset:16896
    s_waitcnt lgkmcnt(6)
    v_mfma_f32_16x16x32_bf16 v[60:63], v[40:43], v[192:195], v[60:63]
    v_mfma_f32_16x16x32_bf16 v[76:79], v[40:43], v[196:199], v[76:79]
    v_mfma_f32_16x16x32_bf16 v[92:95], v[40:43], v[200:203], v[92:95]
    v_mfma_f32_16x16x32_bf16 v[108:111], v[40:43], v[204:207], v[108:111]
    ds_read_b64_tr_b16 v[40:41], v15 offset:16384
    ds_read_b64_tr_b16 v[42:43], v15 offset:16896
    s_waitcnt vmcnt(8)
    s_waitcnt lgkmcnt(6)
    v_mfma_f32_16x16x32_bf16 v[48:51], v[28:31], v[208:211], v[48:51]
    v_mfma_f32_16x16x32_bf16 v[64:67], v[28:31], v[212:215], v[64:67]
    v_mfma_f32_16x16x32_bf16 v[80:83], v[28:31], v[216:219], v[80:83]
    v_mfma_f32_16x16x32_bf16 v[96:99], v[28:31], v[220:223], v[96:99]
    ds_read_b64_tr_b16 v[28:29], v12 offset:20480
    ds_read_b64_tr_b16 v[30:31], v12 offset:20992
    s_waitcnt lgkmcnt(6)
    v_mfma_f32_16x16x32_bf16 v[52:55], v[32:35], v[208:211], v[52:55]
    v_mfma_f32_16x16x32_bf16 v[68:71], v[32:35], v[212:215], v[68:71]
    v_mfma_f32_16x16x32_bf16 v[84:87], v[32:35], v[216:219], v[84:87]
    v_mfma_f32_16x16x32_bf16 v[100:103], v[32:35], v[220:223], v[100:103]
    ds_read_b64_tr_b16 v[32:33], v13 offset:20480
    ds_read_b64_tr_b16 v[34:35], v13 offset:20992
    s_waitcnt lgkmcnt(6)
    v_mfma_f32_16x16x32_bf16 v[56:59], v[36:39], v[208:211], v[56:59]
    v_mfma_f32_16x16x32_bf16 v[72:75], v[36:39], v[212:215], v[72:75]
    v_mfma_f32_16x16x32_bf16 v[88:91], v[36:39], v[216:219], v[88:91]
    v_mfma_f32_16x16x32_bf16 v[104:107], v[36:39], v[220:223], v[104:107]
    ds_read_b64_tr_b16 v[36:37], v14 offset:20480
    ds_read_b64_tr_b16 v[38:39], v14 offset:20992
    s_waitcnt lgkmcnt(6)
    v_mfma_f32_16x16x32_bf16 v[60:63], v[40:43], v[208:211], v[60:63]
    v_mfma_f32_16x16x32_bf16 v[76:79], v[40:43], v[212:215], v[76:79]
    v_mfma_f32_16x16x32_bf16 v[92:95], v[40:43], v[216:219], v[92:95]
    v_mfma_f32_16x16x32_bf16 v[108:111], v[40:43], v[220:223], v[108:111]
    ds_read_b64_tr_b16 v[40:41], v15 offset:20480
    ds_read_b64_tr_b16 v[42:43], v15 offset:20992
    s_waitcnt vmcnt(4)
    s_waitcnt lgkmcnt(6)
    v_mfma_f32_16x16x32_bf16 v[48:51], v[28:31], v[160:163], v[48:51]
    v_mfma_f32_16x16x32_bf16 v[64:67], v[28:31], v[164:167], v[64:67]
    v_mfma_f32_16x16x32_bf16 v[80:83], v[28:31], v[168:171], v[80:83]
    v_mfma_f32_16x16x32_bf16 v[96:99], v[28:31], v[172:175], v[96:99]
    ds_read_b64_tr_b16 v[28:29], v12 offset:24576
    ds_read_b64_tr_b16 v[30:31], v12 offset:25088
    s_waitcnt lgkmcnt(6)
    v_mfma_f32_16x16x32_bf16 v[52:55], v[32:35], v[160:163], v[52:55]
    v_mfma_f32_16x16x32_bf16 v[68:71], v[32:35], v[164:167], v[68:71]
    v_mfma_f32_16x16x32_bf16 v[84:87], v[32:35], v[168:171], v[84:87]
    v_mfma_f32_16x16x32_bf16 v[100:103], v[32:35], v[172:175], v[100:103]
    ds_read_b64_tr_b16 v[32:33], v13 offset:24576
    ds_read_b64_tr_b16 v[34:35], v13 offset:25088
    s_waitcnt lgkmcnt(6)
    v_mfma_f32_16x16x32_bf16 v[56:59], v[36:39], v[160:163], v[56:59]
    v_mfma_f32_16x16x32_bf16 v[72:75], v[36:39], v[164:167], v[72:75]
    v_mfma_f32_16x16x32_bf16 v[88:91], v[36:39], v[168:171], v[88:91]
    v_mfma_f32_16x16x32_bf16 v[104:107], v[36:39], v[172:175], v[104:107]
    ds_read_b64_tr_b16 v[36:37], v14 offset:24576
    ds_read_b64_tr_b16 v[38:39], v14 offset:25088
    s_waitcnt lgkmcnt(6)
    v_mfma_f32_16x16x32_bf16 v[60:63], v[40:43], v[160:163], v[60:63]
    v_mfma_f32_16x16x32_bf16 v[76:79], v[40:43], v[164:167], v[76:79]
    v_mfma_f32_16x16x32_bf16 v[92:95], v[40:43], v[168:171], v[92:95]
    v_mfma_f32_16x16x32_bf16 v[108:111], v[40:43], v[172:175], v[108:111]
    ds_read_b64_tr_b16 v[40:41], v15 offset:24576
    ds_read_b64_tr_b16 v[42:43], v15 offset:25088
    s_waitcnt vmcnt(0)
    s_waitcnt lgkmcnt(0)
    v_mfma_f32_16x16x32_bf16 v[64:67], v[28:31], v[180:183], v[64:67]
    v_mfma_f32_16x16x32_bf16 v[68:71], v[32:35], v[180:183], v[68:71]
    v_mfma_f32_16x16x32_bf16 v[72:75], v[36:39], v[180:183], v[72:75]
    v_mfma_f32_16x16x32_bf16 v[76:79], v[40:43], v[180:183], v[76:79]
    v_mfma_f32_16x16x32_bf16 v[80:83], v[28:31], v[184:187], v[80:83]
    s_nop 3
    ds_write_b128 v47, v[64:67] offset:4096
    v_mfma_f32_16x16x32_bf16 v[84:87], v[32:35], v[184:187], v[84:87]
    ds_write_b128 v47, v[68:71] offset:5120
    v_mfma_f32_16x16x32_bf16 v[88:91], v[36:39], v[184:187], v[88:91]
    ds_write_b128 v47, v[72:75] offset:6144
    v_mfma_f32_16x16x32_bf16 v[92:95], v[40:43], v[184:187], v[92:95]
    ds_write_b128 v47, v[76:79] offset:7168
    v_mfma_f32_16x16x32_bf16 v[96:99], v[28:31], v[188:191], v[96:99]
    ds_write_b128 v47, v[80:83] offset:8192
    v_mfma_f32_16x16x32_bf16 v[100:103], v[32:35], v[188:191], v[100:103]
    ds_write_b128 v47, v[84:87] offset:9216
    v_mfma_f32_16x16x32_bf16 v[104:107], v[36:39], v[188:191], v[104:107]
    ds_write_b128 v47, v[88:91] offset:10240
    v_mfma_f32_16x16x32_bf16 v[108:111], v[40:43], v[188:191], v[108:111]
    ds_write_b128 v47, v[92:95] offset:11264
    v_mfma_f32_16x16x32_bf16 v[48:51], v[28:31], v[176:179], v[48:51]
    ds_write_b128 v47, v[96:99] offset:12288
    v_mfma_f32_16x16x32_bf16 v[52:55], v[32:35], v[176:179], v[52:55]
    v_mfma_f32_16x16x32_bf16 v[56:59], v[36:39], v[176:179], v[56:59]
    v_mfma_f32_16x16x32_bf16 v[60:63], v[40:43], v[176:179], v[60:63]
    ds_write_b128 v47, v[100:103] offset:13312
    ds_write_b128 v47, v[104:107] offset:14336
    ds_write_b128 v47, v[108:111] offset:15360
    ds_write_b32 v45, v44 offset:192
    v_lshlrev_b32 v176, 16, v240
    v_and_b32 v177, 0xffff0000, v240
    v_lshlrev_b32 v178, 16, v241
    v_and_b32 v179, 0xffff0000, v241
    v_lshlrev_b32 v180, 16, v242
    v_and_b32 v181, 0xffff0000, v242
    v_lshlrev_b32 v182, 16, v243
    v_and_b32 v183, 0xffff0000, v243
    v_lshlrev_b32 v184, 16, v244
    v_and_b32 v185, 0xffff0000, v244
    v_lshlrev_b32 v186, 16, v245
    v_and_b32 v187, 0xffff0000, v245
    v_lshlrev_b32 v188, 16, v246
    v_and_b32 v189, 0xffff0000, v246
    v_lshlrev_b32 v190, 16, v247
    v_and_b32 v191, 0xffff0000, v247
    v_pk_add_f32 v[48:49], v[48:49], v[176:177]
    v_pk_add_f32 v[50:51], v[50:51], v[178:179]
    v_pk_add_f32 v[52:53], v[52:53], v[180:181]
    v_pk_add_f32 v[54:55], v[54:55], v[182:183]
    v_pk_add_f32 v[56:57], v[56:57], v[184:185]
    v_pk_add_f32 v[58:59], v[58:59], v[186:187]
    v_pk_add_f32 v[60:61], v[60:61], v[188:189]
    v_pk_add_f32 v[62:63], v[62:63], v[190:191]
    v_lshlrev_b32 v192, 16, v20
    v_and_b32 v193, 0xffff0000, v20
    v_lshlrev_b32 v194, 16, v21
    v_and_b32 v195, 0xffff0000, v21
    v_lshlrev_b32 v196, 16, v22
    v_and_b32 v197, 0xffff0000, v22
    v_lshlrev_b32 v198, 16, v23
    v_and_b32 v199, 0xffff0000, v23
    v_lshlrev_b32 v200, 16, v24
    v_and_b32 v201, 0xffff0000, v24
    v_lshlrev_b32 v202, 16, v25
    v_and_b32 v203, 0xffff0000, v25
    v_lshlrev_b32 v204, 16, v26
    v_and_b32 v205, 0xffff0000, v26
    v_lshlrev_b32 v206, 16, v27
    v_and_b32 v207, 0xffff0000, v27
    v_mov_b32 v232, 0xbfb8aa3b
    v_mov_b32 v234, 1.0
sp_33:
    ds_read_b128 v[8:11], v46 offset:192
    s_waitcnt lgkmcnt(0)
    v_min_u32 v8, v8, v9
    v_min3_u32 v8, v8, v10, v11
    v_cmp_eq_u32 vcc, 1, v8
    s_cbranch_vccnz sp_33_d
    s_add_u32 s72, s72, 1
    s_cmp_lt_u32 s72, 0x80000
    s_cbranch_scc1 sp_33
sp_33_d:
    ds_read_b128 v[128:131], v248 offset:0
    ds_read_b128 v[132:135], v248 offset:1024
    ds_read_b128 v[136:139], v248 offset:2048
    ds_read_b128 v[140:143], v248 offset:3072
    ds_read_b128 v[144:147], v249 offset:0
    ds_read_b128 v[148:151], v249 offset:1024
    ds_read_b128 v[152:155], v249 offset:2048
    ds_read_b128 v[156:159], v249 offset:3072
    ds_read_b128 v[160:163], v250 offset:0
    ds_read_b128 v[164:167], v250 offset:1024
    ds_read_b128 v[168:171], v250 offset:2048
    ds_read_b128 v[172:175], v250 offset:3072
    s_waitcnt lgkmcnt(8)
    v_pk_add_f32 v[48:49], v[48:49], v[128:129]
    v_pk_add_f32 v[50:51], v[50:51], v[130:131]
    v_pk_add_f32 v[52:53], v[52:53], v[132:133]
    v_pk_add_f32 v[54:55], v[54:55], v[134:135]
    v_pk_add_f32 v[56:57], v[56:57], v[136:137]
    v_pk_add_f32 v[58:59], v[58:59], v[138:139]
    v_pk_add_f32 v[60:61], v[60:61], v[140:141]
    v_pk_add_f32 v[62:63], v[62:63], v[142:143]
    s_waitcnt lgkmcnt(4)
    v_pk_add_f32 v[48:49], v[48:49], v[144:145]
    v_pk_add_f32 v[50:51], v[50:51], v[146:147]
    v_pk_add_f32 v[52:53], v[52:53], v[148:149]
    v_pk_add_f32 v[54:55], v[54:55], v[150:151]
    v_pk_add_f32 v[56:57], v[56:57], v[152:153]
    v_pk_add_f32 v[58:59], v[58:59], v[154:155]
    v_pk_add_f32 v[60:61], v[60:61], v[156:157]
    v_pk_add_f32 v[62:63], v[62:63], v[158:159]
    s_waitcnt lgkmcnt(0)
    v_pk_add_f32 v[48:49], v[48:49], v[160:161]
    v_pk_add_f32 v[50:51], v[50:51], v[162:163]
    v_pk_add_f32 v[52:53], v[52:53], v[164:165]
    v_pk_add_f32 v[54:55], v[54:55], v[166:167]
    v_pk_add_f32 v[56:57], v[56:57], v[168:169]
    v_pk_add_f32 v[58:59], v[58:59], v[170:171]
    v_pk_add_f32 v[60:61], v[60:61], v[172:173]
    v_pk_add_f32 v[62:63], v[62:63], v[174:175]
    v_pk_mul_f32 v[128:129], v[48:49], v[232:233] op_sel_hi:[1,0]
    v_pk_mul_f32 v[130:131], v[50:51], v[232:233] op_sel_hi:[1,0]
    v_pk_mul_f32 v[132:133], v[52:53], v[232:233] op_sel_hi:[1,0]
    v_pk_mul_f32 v[134:135], v[54:55], v[232:233] op_sel_hi:[1,0]
    v_pk_mul_f32 v[136:137], v[56:57], v[232:233] op_sel_hi:[1,0]
    v_pk_mul_f32 v[138:139], v[58:59], v[232:233] op_sel_hi:[1,0]
    v_pk_mul_f32 v[140:141], v[60:61], v[232:233] op_sel_hi:[1,0]
    v_pk_mul_f32 v[142:143], v[62:63], v[232:233] op_sel_hi:[1,0]
    v_exp_f32 v128, v128
    v_exp_f32 v129, v129
    v_exp_f32 v130, v130
    v_exp_f32 v131, v131
    v_exp_f32 v132, v132
    v_exp_f32 v133, v133
    v_exp_f32 v134, v134
    v_exp_f32 v135, v135
    v_exp_f32 v136, v136
    v_exp_f32 v137, v137
    v_exp_f32 v138, v138
    v_exp_f32 v139, v139
    v_exp_f32 v140, v140
    v_exp_f32 v141, v141
    v_exp_f32 v142, v142
    v_exp_f32 v143, v143
    v_pk_add_f32 v[128:129], v[128:129], v[234:235] op_sel_hi:[1,0]
    v_pk_add_f32 v[130:131], v[130:131], v[234:235] op_sel_hi:[1,0]
    v_pk_add_f32 v[132:133], v[132:133], v[234:235] op_sel_hi:[1,0]
    v_pk_add_f32 v[134:135], v[134:135], v[234:235] op_sel_hi:[1,0]
    v_pk_add_f32 v[136:137], v[136:137], v[234:235] op_sel_hi:[1,0]
    v_pk_add_f32 v[138:139], v[138:139], v[234:235] op_sel_hi:[1,0]
    v_pk_add_f32 v[140:141], v[140:141], v[234:235] op_sel_hi:[1,0]
    v_pk_add_f32 v[142:143], v[142:143], v[234:235] op_sel_hi:[1,0]
    v_rcp_f32 v128, v128
    v_rcp_f32 v129, v129
    v_rcp_f32 v130, v130
    v_rcp_f32 v131, v131
    v_rcp_f32 v132, v132
    v_rcp_f32 v133, v133
    v_rcp_f32 v134, v134
    v_rcp_f32 v135, v135
    v_rcp_f32 v136, v136
    v_rcp_f32 v137, v137
    v_rcp_f32 v138, v138
    v_rcp_f32 v139, v139
    v_rcp_f32 v140, v140
    v_rcp_f32 v141, v141
    v_rcp_f32 v142, v142
    v_rcp_f32 v143, v143
    v_pk_mul_f32 v[48:49], v[48:49], v[128:129]
    v_pk_mul_f32 v[50:51], v[50:51], v[130:131]
    v_pk_mul_f32 v[52:53], v[52:53], v[132:133]
    v_pk_mul_f32 v[54:55], v[54:55], v[134:135]
    v_pk_mul_f32 v[56:57], v[56:57], v[136:137]
    v_pk_mul_f32 v[58:59], v[58:59], v[138:139]
    v_pk_mul_f32 v[60:61], v[60:61], v[140:141]
    v_pk_mul_f32 v[62:63], v[62:63], v[142:143]
sp_34:
    ds_read_b128 v[8:11], v46 offset:160
    s_waitcnt lgkmcnt(0)
    v_min_u32 v8, v8, v9
    v_min3_u32 v8, v8, v10, v11
    v_cmp_eq_u32 vcc, 1, v8
    s_cbranch_vccnz sp_34_d
    s_add_u32 s72, s72, 1
    s_cmp_lt_u32 s72, 0x80000
    s_cbranch_scc1 sp_34
sp_34_d:
    ds_read_b64_tr_b16 v[224:225], v18 offset:0
    ds_read_b64_tr_b16 v[226:227], v18 offset:2048
    ds_read_b64_tr_b16 v[228:229], v18 offset:12896
    ds_read_b64_tr_b16 v[230:231], v18 offset:14944
    s_waitcnt lgkmcnt(0)
    v_lshlrev_b32 v208, 16, v224
    v_and_b32 v209, 0xffff0000, v224
    v_lshlrev_b32 v210, 16, v225
    v_and_b32 v211, 0xffff0000, v225
    v_lshlrev_b32 v212, 16, v226
    v_and_b32 v213, 0xffff0000, v226
    v_lshlrev_b32 v214, 16, v227
    v_and_b32 v215, 0xffff0000, v227
    v_lshlrev_b32 v216, 16, v228
    v_and_b32 v217, 0xffff0000, v228
    v_lshlrev_b32 v218, 16, v229
    v_and_b32 v219, 0xffff0000, v229
    v_lshlrev_b32 v220, 16, v230
    v_and_b32 v221, 0xffff0000, v230
    v_lshlrev_b32 v222, 16, v231
    v_and_b32 v223, 0xffff0000, v231
    v_pk_mul_f32 v[48:49], v[48:49], v[208:209]
    v_pk_mul_f32 v[50:51], v[50:51], v[210:211]
    v_pk_mul_f32 v[52:53], v[52:53], v[212:213]
    v_pk_mul_f32 v[54:55], v[54:55], v[214:215]
    v_pk_mul_f32 v[56:57], v[56:57], v[216:217]
    v_pk_mul_f32 v[58:59], v[58:59], v[218:219]
    v_pk_mul_f32 v[60:61], v[60:61], v[220:221]
    v_pk_mul_f32 v[62:63], v[62:63], v[222:223]
    v_cvt_pk_bf16_f32 v160, v48, v49
    v_cvt_pk_bf16_f32 v161, v50, v51
    v_cvt_pk_bf16_f32 v162, v52, v53
    v_cvt_pk_bf16_f32 v163, v54, v55
    v_cvt_pk_bf16_f32 v164, v56, v57
    v_cvt_pk_bf16_f32 v165, v58, v59
    v_cvt_pk_bf16_f32 v166, v60, v61
    v_cvt_pk_bf16_f32 v167, v62, v63
    v_permlane16_swap_b32 v160, v162
    v_permlane16_swap_b32 v161, v163
    v_permlane16_swap_b32 v164, v166
    v_permlane16_swap_b32 v165, v167
    v_lshlrev_b32 v128, 16, v160
    v_and_b32 v129, 0xffff0000, v160
    v_lshlrev_b32 v130, 16, v161
    v_and_b32 v131, 0xffff0000, v161
    v_lshlrev_b32 v132, 16, v162
    v_and_b32 v133, 0xffff0000, v162
    v_lshlrev_b32 v134, 16, v163
    v_and_b32 v135, 0xffff0000, v163
    v_lshlrev_b32 v136, 16, v164
    v_and_b32 v137, 0xffff0000, v164
    v_lshlrev_b32 v138, 16, v165
    v_and_b32 v139, 0xffff0000, v165
    v_lshlrev_b32 v140, 16, v166
    v_and_b32 v141, 0xffff0000, v166
    v_lshlrev_b32 v142, 16, v167
    v_and_b32 v143, 0xffff0000, v167
    v_pk_add_f32 v[128:129], v[128:129], v[192:193]
    v_pk_add_f32 v[130:131], v[130:131], v[194:195]
    v_pk_add_f32 v[132:133], v[132:133], v[196:197]
    v_pk_add_f32 v[134:135], v[134:135], v[198:199]
    v_pk_add_f32 v[136:137], v[136:137], v[200:201]
    v_pk_add_f32 v[138:139], v[138:139], v[202:203]
    v_pk_add_f32 v[140:141], v[140:141], v[204:205]
    v_pk_add_f32 v[142:143], v[142:143], v[206:207]
    v_cvt_pk_bf16_f32 v160, v128, v129
    v_cvt_pk_bf16_f32 v161, v130, v131
    v_cvt_pk_bf16_f32 v162, v132, v133
    v_cvt_pk_bf16_f32 v163, v134, v135
    v_cvt_pk_bf16_f32 v164, v136, v137
    v_cvt_pk_bf16_f32 v165, v138, v139
    v_cvt_pk_bf16_f32 v166, v140, v141
    v_cvt_pk_bf16_f32 v167, v142, v143
    buffer_store_dwordx4 v[160:163], v16, s[52:55], 0 offen
    buffer_store_dwordx4 v[164:167], v16, s[52:55], 0 offen offset:64
    s_or_b32 s56, s2, s3
    s_cmp_lg_u32 s56, 0
    s_cbranch_scc1 K_g9
    v_mov_b32 v238, 0
    s_mov_b32 s56, 0x30000
    s_mov_b64 exec, 1
    buffer_store_dword v237, v238, s[60:63], s56 offen sc1
    s_mov_b64 exec, -1
K_g9:
    s_endpgm
K_x:
    s_setprio 3
    s_mov_b32 s32, s4
    s_mov_b32 s33, s5
    s_mov_b32 s34, 2097152
    s_mov_b32 s35, 0x00020000
    s_mov_b32 s36, s24
    s_mov_b32 s37, s25
    s_mov_b32 s38, 2097152
    s_mov_b32 s39, 0x00020000
    s_add_u32 s44, s24, 20971520
    s_addc_u32 s45, s25, 0
    s_mov_b32 s46, 786432
    s_mov_b32 s47, 0x00020000
    v_lshlrev_b32 v2, 4, v1
    v_mov_b32 v60, 0
    s_mov_b32 s40, 0x30000
    buffer_load_dword v61, v60, s[44:47], s40 offen sc1
    s_lshl_b32 s29, s28, 13
    v_add_u32 v3, 4096, v2
    buffer_load_dwordx4 v[160:163], v2, s[32:35], s29 offen offset:0
    buffer_load_dwordx4 v[164:167], v2, s[32:35], s29 offen offset:1024
    buffer_load_dwordx4 v[168:171], v2, s[32:35], s29 offen offset:2048
    buffer_load_dwordx4 v[172:175], v2, s[32:35], s29 offen offset:3072
    buffer_load_dwordx4 v[176:179], v3, s[32:35], s29 offen offset:0
    buffer_load_dwordx4 v[180:183], v3, s[32:35], s29 offen offset:1024
    buffer_load_dwordx4 v[184:187], v3, s[32:35], s29 offen offset:2048
    buffer_load_dwordx4 v[188:191], v3, s[32:35], s29 offen offset:3072
    v_mov_b32 v6, 156864
    s_lshl_b32 s31, s28, 2
    s_load_dword s63, s[18:19], s31
    s_lshl_b32 s31, s28, 9
    s_add_u32 s31, s31, 256
    v_lshlrev_b32 v4, 2, v1
    s_mov_b32 s40, s6
    s_mov_b32 s41, s7
    s_mov_b32 s42, 131072
    s_mov_b32 s43, 0x00020000
    buffer_load_dword v52, v4, s[40:43], s31 offen
    s_mov_b32 s40, s8
    s_mov_b32 s41, s9
    s_mov_b32 s42, 131072
    s_mov_b32 s43, 0x00020000
    buffer_load_dword v53, v4, s[40:43], s31 offen
    s_mov_b32 s40, s10
    s_mov_b32 s41, s11
    s_mov_b32 s42, 131072
    s_mov_b32 s43, 0x00020000
    buffer_load_dword v54, v4, s[40:43], s31 offen
    s_mov_b32 s40, s12
    s_mov_b32 s41, s13
    s_mov_b32 s42, 131072
    s_mov_b32 s43, 0x00020000
    buffer_load_dword v55, v4, s[40:43], s31 offen
    s_mov_b32 s40, s14
    s_mov_b32 s41, s15
    s_mov_b32 s42, 131072
    s_mov_b32 s43, 0x00020000
    buffer_load_dword v56, v4, s[40:43], s31 offen
    s_mov_b32 s40, s16
    s_mov_b32 s41, s17
    s_mov_b32 s42, 131072
    s_mov_b32 s43, 0x00020000
    buffer_load_dword v57, v4, s[40:43], s31 offen
    v_mov_b32 v4, 0x3f803f80
    s_waitcnt vmcnt(14)
    s_setprio 1
    v_add_u32 v61, 1, v61
    v_max_u32 v61, 1, v61
    ds_write_b32 v6, v61 offset:80
    s_waitcnt vmcnt(13)
    v_dot2_f32_bf16 v64, v160, v4, 0
    v_dot2_f32_bf16 v72, v160, v160, 0
    v_dot2_f32_bf16 v64, v161, v4, v64
    v_dot2_f32_bf16 v72, v161, v161, v72
    v_dot2_f32_bf16 v64, v162, v4, v64
    v_dot2_f32_bf16 v72, v162, v162, v72
    v_dot2_f32_bf16 v64, v163, v4, v64
    v_dot2_f32_bf16 v72, v163, v163, v72
    s_waitcnt vmcnt(12)
    v_dot2_f32_bf16 v65, v164, v4, 0
    v_dot2_f32_bf16 v73, v164, v164, 0
    v_dot2_f32_bf16 v65, v165, v4, v65
    v_dot2_f32_bf16 v73, v165, v165, v73
    v_dot2_f32_bf16 v65, v166, v4, v65
    v_dot2_f32_bf16 v73, v166, v166, v73
    v_dot2_f32_bf16 v65, v167, v4, v65
    v_dot2_f32_bf16 v73, v167, v167, v73
    s_waitcnt vmcnt(11)
    v_dot2_f32_bf16 v66, v168, v4, 0
    v_dot2_f32_bf16 v74, v168, v168, 0
    v_dot2_f32_bf16 v66, v169, v4, v66
    v_dot2_f32_bf16 v74, v169, v169, v74
    v_dot2_f32_bf16 v66, v170, v4, v66
    v_dot2_f32_bf16 v74, v170, v170, v74
    v_dot2_f32_bf16 v66, v171, v4, v66
    v_dot2_f32_bf16 v74, v171, v171, v74
    s_waitcnt vmcnt(10)
    v_dot2_f32_bf16 v67, v172, v4, 0
    v_dot2_f32_bf16 v75, v172, v172, 0
    v_dot2_f32_bf16 v67, v173, v4, v67
    v_dot2_f32_bf16 v75, v173, v173, v75
    v_dot2_f32_bf16 v67, v174, v4, v67
    v_dot2_f32_bf16 v75, v174, v174, v75
    v_dot2_f32_bf16 v67, v175, v4, v67
    v_dot2_f32_bf16 v75, v175, v175, v75
    s_waitcnt vmcnt(9)
    v_dot2_f32_bf16 v68, v176, v4, 0
    v_dot2_f32_bf16 v76, v176, v176, 0
    v_dot2_f32_bf16 v68, v177, v4, v68
    v_dot2_f32_bf16 v76, v177, v177, v76
    v_dot2_f32_bf16 v68, v178, v4, v68
    v_dot2_f32_bf16 v76, v178, v178, v76
    v_dot2_f32_bf16 v68, v179, v4, v68
    v_dot2_f32_bf16 v76, v179, v179, v76
    s_waitcnt vmcnt(8)
    v_dot2_f32_bf16 v69, v180, v4, 0
    v_dot2_f32_bf16 v77, v180, v180, 0
    v_dot2_f32_bf16 v69, v181, v4, v69
    v_dot2_f32_bf16 v77, v181, v181, v77
    v_dot2_f32_bf16 v69, v182, v4, v69
    v_dot2_f32_bf16 v77, v182, v182, v77
    v_dot2_f32_bf16 v69, v183, v4, v69
    v_dot2_f32_bf16 v77, v183, v183, v77
    s_waitcnt vmcnt(7)
    v_dot2_f32_bf16 v70, v184, v4, 0
    v_dot2_f32_bf16 v78, v184, v184, 0
    v_dot2_f32_bf16 v70, v185, v4, v70
    v_dot2_f32_bf16 v78, v185, v185, v78
    v_dot2_f32_bf16 v70, v186, v4, v70
    v_dot2_f32_bf16 v78, v186, v186, v78
    v_dot2_f32_bf16 v70, v187, v4, v70
    v_dot2_f32_bf16 v78, v187, v187, v78
    s_waitcnt vmcnt(6)
    v_dot2_f32_bf16 v71, v188, v4, 0
    v_dot2_f32_bf16 v79, v188, v188, 0
    v_dot2_f32_bf16 v71, v189, v4, v71
    v_dot2_f32_bf16 v79, v189, v189, v79
    v_dot2_f32_bf16 v71, v190, v4, v71
    v_dot2_f32_bf16 v79, v190, v190, v79
    v_dot2_f32_bf16 v71, v191, v4, v71
    v_dot2_f32_bf16 v79, v191, v191, v79
    v_permlane32_swap_b32 v64, v68
    v_permlane32_swap_b32 v65, v69
    v_permlane32_swap_b32 v66, v70
    v_permlane32_swap_b32 v67, v71
    v_permlane32_swap_b32 v72, v76
    v_permlane32_swap_b32 v73, v77
    v_permlane32_swap_b32 v74, v78
    v_permlane32_swap_b32 v75, v79
    v_add_f32 v64, v64, v68
    v_add_f32 v65, v65, v69
    v_add_f32 v66, v66, v70
    v_add_f32 v67, v67, v71
    v_add_f32 v72, v72, v76
    v_add_f32 v73, v73, v77
    v_add_f32 v74, v74, v78
    v_add_f32 v75, v75, v79
    v_permlane16_swap_b32 v64, v66
    v_permlane16_swap_b32 v65, v67
    v_permlane16_swap_b32 v72, v74
    v_permlane16_swap_b32 v73, v75
    v_add_f32 v64, v64, v66
    v_add_f32 v65, v65, v67
    v_add_f32 v72, v72, v74
    v_add_f32 v73, v73, v75
    v_add_f32_dpp v64, v64, v64 row_ror:8 row_mask:0xf bank_mask:0xf
    v_add_f32_dpp v65, v65, v65 row_ror:8 row_mask:0xf bank_mask:0xf
    v_add_f32_dpp v72, v72, v72 row_ror:8 row_mask:0xf bank_mask:0xf
    v_add_f32_dpp v73, v73, v73 row_ror:8 row_mask:0xf bank_mask:0xf
    v_add_f32_dpp v64, v64, v64 row_ror:4 row_mask:0xf bank_mask:0xf
    v_add_f32_dpp v65, v65, v65 row_ror:4 row_mask:0xf bank_mask:0xf
    v_add_f32_dpp v72, v72, v72 row_ror:4 row_mask:0xf bank_mask:0xf
    v_add_f32_dpp v73, v73, v73 row_ror:4 row_mask:0xf bank_mask:0xf
    v_add_f32_dpp v64, v64, v64 row_ror:2 row_mask:0xf bank_mask:0xf
    v_add_f32_dpp v65, v65, v65 row_ror:2 row_mask:0xf bank_mask:0xf
    v_add_f32_dpp v72, v72, v72 row_ror:2 row_mask:0xf bank_mask:0xf
    v_add_f32_dpp v73, v73, v73 row_ror:2 row_mask:0xf bank_mask:0xf
    v_add_f32_dpp v64, v64, v64 row_ror:1 row_mask:0xf bank_mask:0xf
    v_add_f32_dpp v65, v65, v65 row_ror:1 row_mask:0xf bank_mask:0xf
    v_add_f32_dpp v72, v72, v72 row_ror:1 row_mask:0xf bank_mask:0xf
    v_add_f32_dpp v73, v73, v73 row_ror:1 row_mask:0xf bank_mask:0xf
    v_mul_f32 v64, 0x3b000000, v64
    v_mul_f32 v65, 0x3b000000, v65
    v_mul_f32 v72, 0x3b000000, v72
    v_mul_f32 v73, 0x3b000000, v73
    v_fma_f32 v72, -v64, v64, v72
    v_fma_f32 v73, -v65, v65, v73
    v_max_f32 v72, 0, v72
    v_max_f32 v73, 0, v73
    v_cvt_pk_bf16_f32 v91, v72, v72
    v_cvt_pk_bf16_f32 v95, v73, v73
    v_lshlrev_b32 v88, 16, v91
    v_lshlrev_b32 v92, 16, v95
    v_add_f32 v88, 0x3727c5ac, v88
    v_add_f32 v92, 0x3727c5ac, v92
    v_cvt_pk_bf16_f32 v91, v88, v88
    v_cvt_pk_bf16_f32 v95, v92, v92
    v_lshlrev_b32 v88, 16, v91
    v_lshlrev_b32 v92, 16, v95
    v_sqrt_f32 v88, v88
    v_sqrt_f32 v92, v92
    v_cvt_pk_bf16_f32 v80, v64, v88
    v_cvt_pk_bf16_f32 v84, v65, v92
    v_and_b32 v88, 0xffff0000, v80
    v_and_b32 v92, 0xffff0000, v84
    v_rcp_f32 v89, v88
    v_rcp_f32 v93, v92
    v_lshlrev_b32 v90, 16, v80
    v_lshlrev_b32 v94, 16, v84
    v_sub_f32 v64, v64, v90
    v_sub_f32 v65, v65, v94
    v_mul_f32 v64, v64, v89
    v_mul_f32 v65, v65, v93
    v_mul_f32 v72, v72, v89
    v_mul_f32 v73, v73, v93
    v_mul_f32 v72, v72, v89
    v_mul_f32 v73, v73, v93
    v_cvt_pk_bf16_f32 v91, v72, v72
    v_cvt_pk_bf16_f32 v95, v73, v73
    v_lshlrev_b32 v72, 16, v91
    v_lshlrev_b32 v73, 16, v95
    v_add_f32 v72, 0x3727c5ac, v72
    v_add_f32 v73, 0x3727c5ac, v73
    v_cvt_pk_bf16_f32 v91, v72, v72
    v_cvt_pk_bf16_f32 v95, v73, v73
    v_lshlrev_b32 v72, 16, v91
    v_lshlrev_b32 v73, 16, v95
    v_sqrt_f32 v72, v72
    v_sqrt_f32 v73, v73
    v_mov_b32 v81, v61
    v_mov_b32 v85, v61
    v_cvt_pk_bf16_f32 v82, v64, v72
    v_cvt_pk_bf16_f32 v86, v65, v73
    v_mov_b32 v83, v61
    v_mov_b32 v87, v61
    v_and_b32 v8, 15, v1
    v_lshlrev_b32 v8, 11, v8
    v_lshrrev_b32 v9, 4, v1
    v_lshl_add_u32 v8, v9, 5, v8
    s_lshr_b32 s41, s28, 4
    s_lshl_b32 s41, s41, 15
    s_and_b32 s42, s28, 15
    s_lshl_b32 s42, s42, 7
    s_add_u32 s41, s41, s42
    s_add_u32 s41, s41, 262144
    buffer_store_dwordx4 v[80:83], v8, s[44:47], s41 offen offset:0 sc1
    buffer_store_dwordx4 v[84:87], v8, s[44:47], s41 offen offset:16 sc1
    v_readlane_b32 s64, v90, 0
    v_readlane_b32 s48, v89, 0
    v_readlane_b32 s66, v90, 16
    v_readlane_b32 s50, v89, 16
    v_readlane_b32 s68, v90, 32
    v_readlane_b32 s52, v89, 32
    v_readlane_b32 s70, v90, 48
    v_readlane_b32 s54, v89, 48
    v_readlane_b32 s65, v94, 0
    v_readlane_b32 s49, v93, 0
    v_readlane_b32 s67, v94, 16
    v_readlane_b32 s51, v93, 16
    v_readlane_b32 s69, v94, 32
    v_readlane_b32 s53, v93, 32
    v_readlane_b32 s71, v94, 48
    v_readlane_b32 s55, v93, 48
    v_lshlrev_b32 v96, 16, v188
    v_and_b32 v97, 0xffff0000, v188
    v_subrev_f32 v96, s71, v96
    v_subrev_f32 v97, s71, v97
    v_cvt_pk_bf16_f32 v188, v96, v97
    v_lshlrev_b32 v96, 16, v188
    v_and_b32 v97, 0xffff0000, v188
    v_mul_f32 v96, s55, v96
    v_mul_f32 v97, s55, v97
    v_lshlrev_b32 v98, 16, v189
    v_and_b32 v99, 0xffff0000, v189
    v_subrev_f32 v98, s71, v98
    v_subrev_f32 v99, s71, v99
    v_cvt_pk_bf16_f32 v189, v98, v99
    v_lshlrev_b32 v98, 16, v189
    v_and_b32 v99, 0xffff0000, v189
    v_mul_f32 v98, s55, v98
    v_mul_f32 v99, s55, v99
    v_lshlrev_b32 v100, 16, v190
    v_and_b32 v101, 0xffff0000, v190
    v_subrev_f32 v100, s71, v100
    v_subrev_f32 v101, s71, v101
    v_cvt_pk_bf16_f32 v190, v100, v101
    v_lshlrev_b32 v100, 16, v190
    v_and_b32 v101, 0xffff0000, v190
    v_mul_f32 v100, s55, v100
    v_mul_f32 v101, s55, v101
    v_lshlrev_b32 v102, 16, v191
    v_and_b32 v103, 0xffff0000, v191
    v_subrev_f32 v102, s71, v102
    v_subrev_f32 v103, s71, v103
    v_cvt_pk_bf16_f32 v191, v102, v103
    v_lshlrev_b32 v102, 16, v191
    v_and_b32 v103, 0xffff0000, v191
    v_mul_f32 v102, s55, v102
    v_mul_f32 v103, s55, v103
    v_lshlrev_b32 v104, 16, v184
    v_and_b32 v105, 0xffff0000, v184
    v_subrev_f32 v104, s70, v104
    v_subrev_f32 v105, s70, v105
    v_cvt_pk_bf16_f32 v184, v104, v105
    v_lshlrev_b32 v104, 16, v184
    v_and_b32 v105, 0xffff0000, v184
    v_mul_f32 v104, s54, v104
    v_mul_f32 v105, s54, v105
    v_lshlrev_b32 v106, 16, v185
    v_and_b32 v107, 0xffff0000, v185
    v_subrev_f32 v106, s70, v106
    v_subrev_f32 v107, s70, v107
    v_cvt_pk_bf16_f32 v185, v106, v107
    v_lshlrev_b32 v106, 16, v185
    v_and_b32 v107, 0xffff0000, v185
    v_mul_f32 v106, s54, v106
    v_mul_f32 v107, s54, v107
    v_lshlrev_b32 v108, 16, v186
    v_and_b32 v109, 0xffff0000, v186
    v_subrev_f32 v108, s70, v108
    v_subrev_f32 v109, s70, v109
    v_cvt_pk_bf16_f32 v186, v108, v109
    v_lshlrev_b32 v108, 16, v186
    v_and_b32 v109, 0xffff0000, v186
    v_mul_f32 v108, s54, v108
    v_mul_f32 v109, s54, v109
    v_lshlrev_b32 v110, 16, v187
    v_and_b32 v111, 0xffff0000, v187
    v_subrev_f32 v110, s70, v110
    v_subrev_f32 v111, s70, v111
    v_cvt_pk_bf16_f32 v187, v110, v111
    v_lshlrev_b32 v110, 16, v187
    v_and_b32 v111, 0xffff0000, v187
    v_mul_f32 v110, s54, v110
    v_mul_f32 v111, s54, v111
    v_cvt_pk_bf16_f32 v112, v96, v104
    v_cvt_pk_bf16_f32 v116, v97, v105
    v_cvt_pk_bf16_f32 v120, v98, v106
    v_cvt_pk_bf16_f32 v124, v99, v107
    v_cvt_pk_bf16_f32 v128, v100, v108
    v_cvt_pk_bf16_f32 v132, v101, v109
    v_cvt_pk_bf16_f32 v136, v102, v110
    v_cvt_pk_bf16_f32 v140, v103, v111
    v_lshlrev_b32 v96, 16, v180
    v_and_b32 v97, 0xffff0000, v180
    v_subrev_f32 v96, s69, v96
    v_subrev_f32 v97, s69, v97
    v_cvt_pk_bf16_f32 v180, v96, v97
    v_lshlrev_b32 v96, 16, v180
    v_and_b32 v97, 0xffff0000, v180
    v_mul_f32 v96, s53, v96
    v_mul_f32 v97, s53, v97
    v_lshlrev_b32 v98, 16, v181
    v_and_b32 v99, 0xffff0000, v181
    v_subrev_f32 v98, s69, v98
    v_subrev_f32 v99, s69, v99
    v_cvt_pk_bf16_f32 v181, v98, v99
    v_lshlrev_b32 v98, 16, v181
    v_and_b32 v99, 0xffff0000, v181
    v_mul_f32 v98, s53, v98
    v_mul_f32 v99, s53, v99
    v_lshlrev_b32 v100, 16, v182
    v_and_b32 v101, 0xffff0000, v182
    v_subrev_f32 v100, s69, v100
    v_subrev_f32 v101, s69, v101
    v_cvt_pk_bf16_f32 v182, v100, v101
    v_lshlrev_b32 v100, 16, v182
    v_and_b32 v101, 0xffff0000, v182
    v_mul_f32 v100, s53, v100
    v_mul_f32 v101, s53, v101
    v_lshlrev_b32 v102, 16, v183
    v_and_b32 v103, 0xffff0000, v183
    v_subrev_f32 v102, s69, v102
    v_subrev_f32 v103, s69, v103
    v_cvt_pk_bf16_f32 v183, v102, v103
    v_lshlrev_b32 v102, 16, v183
    v_and_b32 v103, 0xffff0000, v183
    v_mul_f32 v102, s53, v102
    v_mul_f32 v103, s53, v103
    v_lshlrev_b32 v104, 16, v176
    v_and_b32 v105, 0xffff0000, v176
    v_subrev_f32 v104, s68, v104
    v_subrev_f32 v105, s68, v105
    v_cvt_pk_bf16_f32 v176, v104, v105
    v_lshlrev_b32 v104, 16, v176
    v_and_b32 v105, 0xffff0000, v176
    v_mul_f32 v104, s52, v104
    v_mul_f32 v105, s52, v105
    v_lshlrev_b32 v106, 16, v177
    v_and_b32 v107, 0xffff0000, v177
    v_subrev_f32 v106, s68, v106
    v_subrev_f32 v107, s68, v107
    v_cvt_pk_bf16_f32 v177, v106, v107
    v_lshlrev_b32 v106, 16, v177
    v_and_b32 v107, 0xffff0000, v177
    v_mul_f32 v106, s52, v106
    v_mul_f32 v107, s52, v107
    v_lshlrev_b32 v108, 16, v178
    v_and_b32 v109, 0xffff0000, v178
    v_subrev_f32 v108, s68, v108
    v_subrev_f32 v109, s68, v109
    v_cvt_pk_bf16_f32 v178, v108, v109
    v_lshlrev_b32 v108, 16, v178
    v_and_b32 v109, 0xffff0000, v178
    v_mul_f32 v108, s52, v108
    v_mul_f32 v109, s52, v109
    v_lshlrev_b32 v110, 16, v179
    v_and_b32 v111, 0xffff0000, v179
    v_subrev_f32 v110, s68, v110
    v_subrev_f32 v111, s68, v111
    v_cvt_pk_bf16_f32 v179, v110, v111
    v_lshlrev_b32 v110, 16, v179
    v_and_b32 v111, 0xffff0000, v179
    v_mul_f32 v110, s52, v110
    v_mul_f32 v111, s52, v111
    v_cvt_pk_bf16_f32 v113, v96, v104
    v_cvt_pk_bf16_f32 v117, v97, v105
    v_cvt_pk_bf16_f32 v121, v98, v106
    v_cvt_pk_bf16_f32 v125, v99, v107
    v_cvt_pk_bf16_f32 v129, v100, v108
    v_cvt_pk_bf16_f32 v133, v101, v109
    v_cvt_pk_bf16_f32 v137, v102, v110
    v_cvt_pk_bf16_f32 v141, v103, v111
    v_lshlrev_b32 v96, 16, v172
    v_and_b32 v97, 0xffff0000, v172
    v_subrev_f32 v96, s67, v96
    v_subrev_f32 v97, s67, v97
    v_cvt_pk_bf16_f32 v172, v96, v97
    v_lshlrev_b32 v96, 16, v172
    v_and_b32 v97, 0xffff0000, v172
    v_mul_f32 v96, s51, v96
    v_mul_f32 v97, s51, v97
    v_lshlrev_b32 v98, 16, v173
    v_and_b32 v99, 0xffff0000, v173
    v_subrev_f32 v98, s67, v98
    v_subrev_f32 v99, s67, v99
    v_cvt_pk_bf16_f32 v173, v98, v99
    v_lshlrev_b32 v98, 16, v173
    v_and_b32 v99, 0xffff0000, v173
    v_mul_f32 v98, s51, v98
    v_mul_f32 v99, s51, v99
    v_lshlrev_b32 v100, 16, v174
    v_and_b32 v101, 0xffff0000, v174
    v_subrev_f32 v100, s67, v100
    v_subrev_f32 v101, s67, v101
    v_cvt_pk_bf16_f32 v174, v100, v101
    v_lshlrev_b32 v100, 16, v174
    v_and_b32 v101, 0xffff0000, v174
    v_mul_f32 v100, s51, v100
    v_mul_f32 v101, s51, v101
    v_lshlrev_b32 v102, 16, v175
    v_and_b32 v103, 0xffff0000, v175
    v_subrev_f32 v102, s67, v102
    v_subrev_f32 v103, s67, v103
    v_cvt_pk_bf16_f32 v175, v102, v103
    v_lshlrev_b32 v102, 16, v175
    v_and_b32 v103, 0xffff0000, v175
    v_mul_f32 v102, s51, v102
    v_mul_f32 v103, s51, v103
    v_lshlrev_b32 v104, 16, v168
    v_and_b32 v105, 0xffff0000, v168
    v_subrev_f32 v104, s66, v104
    v_subrev_f32 v105, s66, v105
    v_cvt_pk_bf16_f32 v168, v104, v105
    v_lshlrev_b32 v104, 16, v168
    v_and_b32 v105, 0xffff0000, v168
    v_mul_f32 v104, s50, v104
    v_mul_f32 v105, s50, v105
    v_lshlrev_b32 v106, 16, v169
    v_and_b32 v107, 0xffff0000, v169
    v_subrev_f32 v106, s66, v106
    v_subrev_f32 v107, s66, v107
    v_cvt_pk_bf16_f32 v169, v106, v107
    v_lshlrev_b32 v106, 16, v169
    v_and_b32 v107, 0xffff0000, v169
    v_mul_f32 v106, s50, v106
    v_mul_f32 v107, s50, v107
    v_lshlrev_b32 v108, 16, v170
    v_and_b32 v109, 0xffff0000, v170
    v_subrev_f32 v108, s66, v108
    v_subrev_f32 v109, s66, v109
    v_cvt_pk_bf16_f32 v170, v108, v109
    v_lshlrev_b32 v108, 16, v170
    v_and_b32 v109, 0xffff0000, v170
    v_mul_f32 v108, s50, v108
    v_mul_f32 v109, s50, v109
    v_lshlrev_b32 v110, 16, v171
    v_and_b32 v111, 0xffff0000, v171
    v_subrev_f32 v110, s66, v110
    v_subrev_f32 v111, s66, v111
    v_cvt_pk_bf16_f32 v171, v110, v111
    v_lshlrev_b32 v110, 16, v171
    v_and_b32 v111, 0xffff0000, v171
    v_mul_f32 v110, s50, v110
    v_mul_f32 v111, s50, v111
    v_cvt_pk_bf16_f32 v114, v96, v104
    v_cvt_pk_bf16_f32 v118, v97, v105
    v_cvt_pk_bf16_f32 v122, v98, v106
    v_cvt_pk_bf16_f32 v126, v99, v107
    v_cvt_pk_bf16_f32 v130, v100, v108
    v_cvt_pk_bf16_f32 v134, v101, v109
    v_cvt_pk_bf16_f32 v138, v102, v110
    v_cvt_pk_bf16_f32 v142, v103, v111
    v_lshlrev_b32 v96, 16, v164
    v_and_b32 v97, 0xffff0000, v164
    v_subrev_f32 v96, s65, v96
    v_subrev_f32 v97, s65, v97
    v_cvt_pk_bf16_f32 v164, v96, v97
    v_lshlrev_b32 v96, 16, v164
    v_and_b32 v97, 0xffff0000, v164
    v_mul_f32 v96, s49, v96
    v_mul_f32 v97, s49, v97
    v_lshlrev_b32 v98, 16, v165
    v_and_b32 v99, 0xffff0000, v165
    v_subrev_f32 v98, s65, v98
    v_subrev_f32 v99, s65, v99
    v_cvt_pk_bf16_f32 v165, v98, v99
    v_lshlrev_b32 v98, 16, v165
    v_and_b32 v99, 0xffff0000, v165
    v_mul_f32 v98, s49, v98
    v_mul_f32 v99, s49, v99
    v_lshlrev_b32 v100, 16, v166
    v_and_b32 v101, 0xffff0000, v166
    v_subrev_f32 v100, s65, v100
    v_subrev_f32 v101, s65, v101
    v_cvt_pk_bf16_f32 v166, v100, v101
    v_lshlrev_b32 v100, 16, v166
    v_and_b32 v101, 0xffff0000, v166
    v_mul_f32 v100, s49, v100
    v_mul_f32 v101, s49, v101
    v_lshlrev_b32 v102, 16, v167
    v_and_b32 v103, 0xffff0000, v167
    v_subrev_f32 v102, s65, v102
    v_subrev_f32 v103, s65, v103
    v_cvt_pk_bf16_f32 v167, v102, v103
    v_lshlrev_b32 v102, 16, v167
    v_and_b32 v103, 0xffff0000, v167
    v_mul_f32 v102, s49, v102
    v_mul_f32 v103, s49, v103
    v_lshlrev_b32 v104, 16, v160
    v_and_b32 v105, 0xffff0000, v160
    v_subrev_f32 v104, s64, v104
    v_subrev_f32 v105, s64, v105
    v_cvt_pk_bf16_f32 v160, v104, v105
    v_lshlrev_b32 v104, 16, v160
    v_and_b32 v105, 0xffff0000, v160
    v_mul_f32 v104, s48, v104
    v_mul_f32 v105, s48, v105
    v_lshlrev_b32 v106, 16, v161
    v_and_b32 v107, 0xffff0000, v161
    v_subrev_f32 v106, s64, v106
    v_subrev_f32 v107, s64, v107
    v_cvt_pk_bf16_f32 v161, v106, v107
    v_lshlrev_b32 v106, 16, v161
    v_and_b32 v107, 0xffff0000, v161
    v_mul_f32 v106, s48, v106
    v_mul_f32 v107, s48, v107
    v_lshlrev_b32 v108, 16, v162
    v_and_b32 v109, 0xffff0000, v162
    v_subrev_f32 v108, s64, v108
    v_subrev_f32 v109, s64, v109
    v_cvt_pk_bf16_f32 v162, v108, v109
    v_lshlrev_b32 v108, 16, v162
    v_and_b32 v109, 0xffff0000, v162
    v_mul_f32 v108, s48, v108
    v_mul_f32 v109, s48, v109
    v_lshlrev_b32 v110, 16, v163
    v_and_b32 v111, 0xffff0000, v163
    v_subrev_f32 v110, s64, v110
    v_subrev_f32 v111, s64, v111
    v_cvt_pk_bf16_f32 v163, v110, v111
    v_lshlrev_b32 v110, 16, v163
    v_and_b32 v111, 0xffff0000, v163
    v_mul_f32 v110, s48, v110
    v_mul_f32 v111, s48, v111
    v_cvt_pk_bf16_f32 v115, v96, v104
    v_cvt_pk_bf16_f32 v119, v97, v105
    v_cvt_pk_bf16_f32 v123, v98, v106
    v_cvt_pk_bf16_f32 v127, v99, v107
    v_cvt_pk_bf16_f32 v131, v100, v108
    v_cvt_pk_bf16_f32 v135, v101, v109
    v_cvt_pk_bf16_f32 v139, v102, v110
    v_cvt_pk_bf16_f32 v143, v103, v111
    buffer_store_dwordx4 v[112:115], v2, s[36:39], s29 offen offset:0 sc1
    buffer_store_dwordx4 v[116:119], v2, s[36:39], s29 offen offset:1024 sc1
    buffer_store_dwordx4 v[120:123], v2, s[36:39], s29 offen offset:2048 sc1
    buffer_store_dwordx4 v[124:127], v2, s[36:39], s29 offen offset:3072 sc1
    buffer_store_dwordx4 v[128:131], v3, s[36:39], s29 offen offset:0 sc1
    buffer_store_dwordx4 v[132:135], v3, s[36:39], s29 offen offset:1024 sc1
    buffer_store_dwordx4 v[136:139], v3, s[36:39], s29 offen offset:2048 sc1
    buffer_store_dwordx4 v[140:143], v3, s[36:39], s29 offen offset:3072 sc1
    s_lshl_b32 s42, s28, 2
    s_add_u32 s42, s42, 0x8000
sp_35:
    ds_read_b32 v9, v6 offset:240
    s_waitcnt lgkmcnt(0)
    v_cmp_eq_u32 vcc, 1, v9
    s_cbranch_vccnz sp_35_d
    s_sleep 1
    s_add_u32 s72, s72, 1
    s_cmp_lt_u32 s72, 0x80000
    s_cbranch_scc1 sp_35
sp_35_d:
    s_waitcnt vmcnt(0)
    s_mov_b64 exec, 1
    buffer_store_dword v61, v60, s[44:47], s42 offen sc1
    s_mov_b64 exec, -1
    s_mov_b32 s29, 1
    s_branch K_k6
K_kgen:
    s_cmp_eq_u32 s3, 5
    s_cbranch_scc1 K_k5
    s_setprio 3
    s_mov_b32 s36, s4
    s_mov_b32 s37, s5
    s_mov_b32 s38, 2097152
    s_mov_b32 s39, 0x00020000
    v_and_b32 v2, 15, v1
    v_lshrrev_b32 v3, 4, v1
    s_mul_i32 s53, s83, 224
    s_and_b32 s53, s53, 0xffffffc0
    v_mul_u32_u24 v4, 3584, v3
    v_add_u32 v4, s53, v4
    v_lshlrev_b32 v5, 1, v3
    v_xor_b32 v5, v5, v2
    v_xor_b32 v6, 0, v5
    v_lshl_add_u32 v8, v6, 4, v4
    v_xor_b32 v6, 0, v5
    v_lshl_add_u32 v9, v6, 4, v4
    v_add_u32 v9, 13312, v9
    v_xor_b32 v6, 8, v5
    v_lshl_add_u32 v10, v6, 4, v4
    v_add_u32 v10, 26624, v10
    v_xor_b32 v6, 8, v5
    v_lshl_add_u32 v11, v6, 4, v4
    v_add_u32 v11, 39936, v11
    v_lshrrev_b32 v4, 3, v1
    v_and_b32 v6, 7, v1
    v_xor_b32 v5, v3, v6
    s_lshl_b32 s52, s82, 7
    v_add_u32 v4, s52, v4
    v_lshlrev_b32 v4, 10, v4
    v_xor_b32 v6, 0, v5
    v_lshl_add_u32 v12, v6, 4, v4
    v_xor_b32 v6, 4, v5
    v_lshl_add_u32 v13, v6, 4, v4
    v_add_u32 v13, 7168, v13
    v_xor_b32 v6, 0, v5
    v_lshl_add_u32 v14, v6, 4, v4
    v_add_u32 v14, 14336, v14
    v_xor_b32 v6, 4, v5
    v_lshl_add_u32 v15, v6, 4, v4
    v_add_u32 v15, 21504, v15
    v_mov_b32 v16, 1
    v_mov_b32 v17, 156864
    s_mov_b32 m0, 16384
    s_mov_b32 s57, 0
    buffer_load_dwordx4 v12, s[36:39], s57 offen offset:0 lds
    buffer_load_dwordx4 v13, s[36:39], s57 offen offset:1024 lds
    buffer_load_dwordx4 v14, s[36:39], s57 offen offset:2048 lds
    buffer_load_dwordx4 v15, s[36:39], s57 offen offset:3072 lds
    s_mov_b32 m0, 20480
    s_mov_b32 s57, 32768
    buffer_load_dwordx4 v12, s[36:39], s57 offen offset:0 lds
    buffer_load_dwordx4 v13, s[36:39], s57 offen offset:1024 lds
    buffer_load_dwordx4 v14, s[36:39], s57 offen offset:2048 lds
    buffer_load_dwordx4 v15, s[36:39], s57 offen offset:3072 lds
    s_mov_b32 m0, 24576
    s_mov_b32 s57, 65536
    buffer_load_dwordx4 v12, s[36:39], s57 offen offset:0 lds
    buffer_load_dwordx4 v13, s[36:39], s57 offen offset:1024 lds
    buffer_load_dwordx4 v14, s[36:39], s57 offen offset:2048 lds
    buffer_load_dwordx4 v15, s[36:39], s57 offen offset:3072 lds
    s_mov_b32 m0, 28672
    s_mov_b32 s57, 98304
    buffer_load_dwordx4 v12, s[36:39], s57 offen offset:0 lds
    buffer_load_dwordx4 v13, s[36:39], s57 offen offset:1024 lds
    buffer_load_dwordx4 v14, s[36:39], s57 offen offset:2048 lds
    buffer_load_dwordx4 v15, s[36:39], s57 offen offset:3072 lds
    s_mov_b32 m0, 49152
    s_mov_b32 s57, 128
    buffer_load_dwordx4 v12, s[36:39], s57 offen offset:0 lds
    buffer_load_dwordx4 v13, s[36:39], s57 offen offset:1024 lds
    buffer_load_dwordx4 v14, s[36:39], s57 offen offset:2048 lds
    buffer_load_dwordx4 v15, s[36:39], s57 offen offset:3072 lds
    s_mov_b32 m0, 53248
    s_mov_b32 s57, 32896
    buffer_load_dwordx4 v12, s[36:39], s57 offen offset:0 lds
    buffer_load_dwordx4 v13, s[36:39], s57 offen offset:1024 lds
    buffer_load_dwordx4 v14, s[36:39], s57 offen offset:2048 lds
    buffer_load_dwordx4 v15, s[36:39], s57 offen offset:3072 lds
    s_waitcnt vmcnt(8)
    ds_write_b32 v17, v16 offset:208
    s_mov_b32 m0, 57344
    s_mov_b32 s57, 65664
    buffer_load_dwordx4 v12, s[36:39], s57 offen offset:0 lds
    buffer_load_dwordx4 v13, s[36:39], s57 offen offset:1024 lds
    buffer_load_dwordx4 v14, s[36:39], s57 offen offset:2048 lds
    buffer_load_dwordx4 v15, s[36:39], s57 offen offset:3072 lds
    s_mov_b32 m0, 61440
    s_mov_b32 s57, 98432
    buffer_load_dwordx4 v12, s[36:39], s57 offen offset:0 lds
    buffer_load_dwordx4 v13, s[36:39], s57 offen offset:1024 lds
    buffer_load_dwordx4 v14, s[36:39], s57 offen offset:2048 lds
    buffer_load_dwordx4 v15, s[36:39], s57 offen offset:3072 lds
    s_mov_b32 m0, 81920
    s_mov_b32 s57, 256
    buffer_load_dwordx4 v12, s[36:39], s57 offen offset:0 lds
    buffer_load_dwordx4 v13, s[36:39], s57 offen offset:1024 lds
    buffer_load_dwordx4 v14, s[36:39], s57 offen offset:2048 lds
    buffer_load_dwordx4 v15, s[36:39], s57 offen offset:3072 lds
    s_mov_b32 m0, 86016
    s_mov_b32 s57, 33024
    buffer_load_dwordx4 v12, s[36:39], s57 offen offset:0 lds
    buffer_load_dwordx4 v13, s[36:39], s57 offen offset:1024 lds
    buffer_load_dwordx4 v14, s[36:39], s57 offen offset:2048 lds
    buffer_load_dwordx4 v15, s[36:39], s57 offen offset:3072 lds
    s_waitcnt vmcnt(8)
    ds_write_b32 v17, v16 offset:212
    s_mov_b32 m0, 90112
    s_mov_b32 s57, 65792
    buffer_load_dwordx4 v12, s[36:39], s57 offen offset:0 lds
    buffer_load_dwordx4 v13, s[36:39], s57 offen offset:1024 lds
    buffer_load_dwordx4 v14, s[36:39], s57 offen offset:2048 lds
    buffer_load_dwordx4 v15, s[36:39], s57 offen offset:3072 lds
    s_mov_b32 m0, 94208
    s_mov_b32 s57, 98560
    buffer_load_dwordx4 v12, s[36:39], s57 offen offset:0 lds
    buffer_load_dwordx4 v13, s[36:39], s57 offen offset:1024 lds
    buffer_load_dwordx4 v14, s[36:39], s57 offen offset:2048 lds
    buffer_load_dwordx4 v15, s[36:39], s57 offen offset:3072 lds
    s_mov_b32 m0, 114688
    s_mov_b32 s57, 384
    buffer_load_dwordx4 v12, s[36:39], s57 offen offset:0 lds
    buffer_load_dwordx4 v13, s[36:39], s57 offen offset:1024 lds
    buffer_load_dwordx4 v14, s[36:39], s57 offen offset:2048 lds
    buffer_load_dwordx4 v15, s[36:39], s57 offen offset:3072 lds
    s_mov_b32 m0, 118784
    s_mov_b32 s57, 33152
    buffer_load_dwordx4 v12, s[36:39], s57 offen offset:0 lds
    buffer_load_dwordx4 v13, s[36:39], s57 offen offset:1024 lds
    buffer_load_dwordx4 v14, s[36:39], s57 offen offset:2048 lds
    buffer_load_dwordx4 v15, s[36:39], s57 offen offset:3072 lds
    s_waitcnt vmcnt(8)
    ds_write_b32 v17, v16 offset:216
    s_mov_b32 m0, 122880
    s_mov_b32 s57, 65920
    buffer_load_dwordx4 v12, s[36:39], s57 offen offset:0 lds
    buffer_load_dwordx4 v13, s[36:39], s57 offen offset:1024 lds
    buffer_load_dwordx4 v14, s[36:39], s57 offen offset:2048 lds
    buffer_load_dwordx4 v15, s[36:39], s57 offen offset:3072 lds
    s_mov_b32 m0, 126976
    s_mov_b32 s57, 98688
    buffer_load_dwordx4 v12, s[36:39], s57 offen offset:0 lds
    buffer_load_dwordx4 v13, s[36:39], s57 offen offset:1024 lds
    buffer_load_dwordx4 v14, s[36:39], s57 offen offset:2048 lds
    buffer_load_dwordx4 v15, s[36:39], s57 offen offset:3072 lds
    ds_read_b128 v[20:23], v17 offset:32
    s_waitcnt lgkmcnt(0)
    v_min_u32 v20, v20, v21
    v_min3_u32 v20, v20, v22, v23
    v_cmp_le_u32 vcc, 1, v20
    s_cbranch_vccnz ad_36
    s_waitcnt vmcnt(0)
    ds_write_b32 v17, v16 offset:220
fr_37:
    ds_read_b128 v[20:23], v17 offset:32
    s_waitcnt lgkmcnt(0)
    v_min_u32 v20, v20, v21
    v_min3_u32 v20, v20, v22, v23
    v_cmp_le_u32 vcc, 1, v20
    s_cbranch_vccnz fr_37_d
    s_sleep 2
    s_add_u32 s72, s72, 1
    s_cmp_lt_u32 s72, 0x80000
    s_cbranch_scc1 fr_37
fr_37_d:
ad_36:
    s_mov_b32 m0, 16384
    s_mov_b32 s57, 512
    buffer_load_dwordx4 v12, s[36:39], s57 offen offset:0 lds
    buffer_load_dwordx4 v13, s[36:39], s57 offen offset:1024 lds
    buffer_load_dwordx4 v14, s[36:39], s57 offen offset:2048 lds
    buffer_load_dwordx4 v15, s[36:39], s57 offen offset:3072 lds
    s_mov_b32 m0, 20480
    s_mov_b32 s57, 33280
    buffer_load_dwordx4 v12, s[36:39], s57 offen offset:0 lds
    buffer_load_dwordx4 v13, s[36:39], s57 offen offset:1024 lds
    buffer_load_dwordx4 v14, s[36:39], s57 offen offset:2048 lds
    buffer_load_dwordx4 v15, s[36:39], s57 offen offset:3072 lds
    s_waitcnt vmcnt(8)
    ds_write_b32 v17, v16 offset:220
    s_mov_b32 m0, 24576
    s_mov_b32 s57, 66048
    buffer_load_dwordx4 v12, s[36:39], s57 offen offset:0 lds
    buffer_load_dwordx4 v13, s[36:39], s57 offen offset:1024 lds
    buffer_load_dwordx4 v14, s[36:39], s57 offen offset:2048 lds
    buffer_load_dwordx4 v15, s[36:39], s57 offen offset:3072 lds
    s_mov_b32 m0, 28672
    s_mov_b32 s57, 98816
    buffer_load_dwordx4 v12, s[36:39], s57 offen offset:0 lds
    buffer_load_dwordx4 v13, s[36:39], s57 offen offset:1024 lds
    buffer_load_dwordx4 v14, s[36:39], s57 offen offset:2048 lds
    buffer_load_dwordx4 v15, s[36:39], s57 offen offset:3072 lds
    ds_read_b128 v[20:23], v17 offset:32
    s_waitcnt lgkmcnt(0)
    v_min_u32 v20, v20, v21
    v_min3_u32 v20, v20, v22, v23
    v_cmp_le_u32 vcc, 2, v20
    s_cbranch_vccnz ad_38
    s_waitcnt vmcnt(0)
    ds_write_b32 v17, v16 offset:224
fr_39:
    ds_read_b128 v[20:23], v17 offset:32
    s_waitcnt lgkmcnt(0)
    v_min_u32 v20, v20, v21
    v_min3_u32 v20, v20, v22, v23
    v_cmp_le_u32 vcc, 2, v20
    s_cbranch_vccnz fr_39_d
    s_sleep 2
    s_add_u32 s72, s72, 1
    s_cmp_lt_u32 s72, 0x80000
    s_cbranch_scc1 fr_39
fr_39_d:
ad_38:
    s_mov_b32 m0, 49152
    s_mov_b32 s57, 640
    buffer_load_dwordx4 v12, s[36:39], s57 offen offset:0 lds
    buffer_load_dwordx4 v13, s[36:39], s57 offen offset:1024 lds
    buffer_load_dwordx4 v14, s[36:39], s57 offen offset:2048 lds
    buffer_load_dwordx4 v15, s[36:39], s57 offen offset:3072 lds
    s_mov_b32 m0, 53248
    s_mov_b32 s57, 33408
    buffer_load_dwordx4 v12, s[36:39], s57 offen offset:0 lds
    buffer_load_dwordx4 v13, s[36:39], s57 offen offset:1024 lds
    buffer_load_dwordx4 v14, s[36:39], s57 offen offset:2048 lds
    buffer_load_dwordx4 v15, s[36:39], s57 offen offset:3072 lds
    s_waitcnt vmcnt(8)
    ds_write_b32 v17, v16 offset:224
    s_mov_b32 m0, 57344
    s_mov_b32 s57, 66176
    buffer_load_dwordx4 v12, s[36:39], s57 offen offset:0 lds
    buffer_load_dwordx4 v13, s[36:39], s57 offen offset:1024 lds
    buffer_load_dwordx4 v14, s[36:39], s57 offen offset:2048 lds
    buffer_load_dwordx4 v15, s[36:39], s57 offen offset:3072 lds
    s_mov_b32 m0, 61440
    s_mov_b32 s57, 98944
    buffer_load_dwordx4 v12, s[36:39], s57 offen offset:0 lds
    buffer_load_dwordx4 v13, s[36:39], s57 offen offset:1024 lds
    buffer_load_dwordx4 v14, s[36:39], s57 offen offset:2048 lds
    buffer_load_dwordx4 v15, s[36:39], s57 offen offset:3072 lds
    ds_read_b128 v[20:23], v17 offset:32
    s_waitcnt lgkmcnt(0)
    v_min_u32 v20, v20, v21
    v_min3_u32 v20, v20, v22, v23
    v_cmp_le_u32 vcc, 3, v20
    s_cbranch_vccnz ad_40
    s_waitcnt vmcnt(0)
    ds_write_b32 v17, v16 offset:228
fr_41:
    ds_read_b128 v[20:23], v17 offset:32
    s_waitcnt lgkmcnt(0)
    v_min_u32 v20, v20, v21
    v_min3_u32 v20, v20, v22, v23
    v_cmp_le_u32 vcc, 3, v20
    s_cbranch_vccnz fr_41_d
    s_sleep 2
    s_add_u32 s72, s72, 1
    s_cmp_lt_u32 s72, 0x80000
    s_cbranch_scc1 fr_41
fr_41_d:
ad_40:
    s_mov_b32 m0, 81920
    s_mov_b32 s57, 768
    buffer_load_dwordx4 v12, s[36:39], s57 offen offset:0 lds
    buffer_load_dwordx4 v13, s[36:39], s57 offen offset:1024 lds
    buffer_load_dwordx4 v14, s[36:39], s57 offen offset:2048 lds
    buffer_load_dwordx4 v15, s[36:39], s57 offen offset:3072 lds
    s_mov_b32 m0, 86016
    s_mov_b32 s57, 33536
    buffer_load_dwordx4 v12, s[36:39], s57 offen offset:0 lds
    buffer_load_dwordx4 v13, s[36:39], s57 offen offset:1024 lds
    buffer_load_dwordx4 v14, s[36:39], s57 offen offset:2048 lds
    buffer_load_dwordx4 v15, s[36:39], s57 offen offset:3072 lds
    s_waitcnt vmcnt(8)
    ds_write_b32 v17, v16 offset:228
    s_mov_b32 m0, 90112
    s_mov_b32 s57, 66304
    buffer_load_dwordx4 v12, s[36:39], s57 offen offset:0 lds
    buffer_load_dwordx4 v13, s[36:39], s57 offen offset:1024 lds
    buffer_load_dwordx4 v14, s[36:39], s57 offen offset:2048 lds
    buffer_load_dwordx4 v15, s[36:39], s57 offen offset:3072 lds
    s_mov_b32 m0, 94208
    s_mov_b32 s57, 99072
    buffer_load_dwordx4 v12, s[36:39], s57 offen offset:0 lds
    buffer_load_dwordx4 v13, s[36:39], s57 offen offset:1024 lds
    buffer_load_dwordx4 v14, s[36:39], s57 offen offset:2048 lds
    buffer_load_dwordx4 v15, s[36:39], s57 offen offset:3072 lds
    ds_read_b128 v[20:23], v17 offset:32
    s_waitcnt lgkmcnt(0)
    v_min_u32 v20, v20, v21
    v_min3_u32 v20, v20, v22, v23
    v_cmp_le_u32 vcc, 4, v20
    s_cbranch_vccnz ad_42
    s_waitcnt vmcnt(0)
    ds_write_b32 v17, v16 offset:232
fr_43:
    ds_read_b128 v[20:23], v17 offset:32
    s_waitcnt lgkmcnt(0)
    v_min_u32 v20, v20, v21
    v_min3_u32 v20, v20, v22, v23
    v_cmp_le_u32 vcc, 4, v20
    s_cbranch_vccnz fr_43_d
    s_sleep 2
    s_add_u32 s72, s72, 1
    s_cmp_lt_u32 s72, 0x80000
    s_cbranch_scc1 fr_43
fr_43_d:
ad_42:
    s_mov_b32 m0, 114688
    s_mov_b32 s57, 896
    buffer_load_dwordx4 v12, s[36:39], s57 offen offset:0 lds
    buffer_load_dwordx4 v13, s[36:39], s57 offen offset:1024 lds
    buffer_load_dwordx4 v14, s[36:39], s57 offen offset:2048 lds
    buffer_load_dwordx4 v15, s[36:39], s57 offen offset:3072 lds
    s_mov_b32 m0, 118784
    s_mov_b32 s57, 33664
    buffer_load_dwordx4 v12, s[36:39], s57 offen offset:0 lds
    buffer_load_dwordx4 v13, s[36:39], s57 offen offset:1024 lds
    buffer_load_dwordx4 v14, s[36:39], s57 offen offset:2048 lds
    buffer_load_dwordx4 v15, s[36:39], s57 offen offset:3072 lds
    s_waitcnt vmcnt(8)
    ds_write_b32 v17, v16 offset:232
    s_mov_b32 m0, 122880
    s_mov_b32 s57, 66432
    buffer_load_dwordx4 v12, s[36:39], s57 offen offset:0 lds
    buffer_load_dwordx4 v13, s[36:39], s57 offen offset:1024 lds
    buffer_load_dwordx4 v14, s[36:39], s57 offen offset:2048 lds
    buffer_load_dwordx4 v15, s[36:39], s57 offen offset:3072 lds
    s_mov_b32 m0, 126976
    s_mov_b32 s57, 99200
    buffer_load_dwordx4 v12, s[36:39], s57 offen offset:0 lds
    buffer_load_dwordx4 v13, s[36:39], s57 offen offset:1024 lds
    buffer_load_dwordx4 v14, s[36:39], s57 offen offset:2048 lds
    buffer_load_dwordx4 v15, s[36:39], s57 offen offset:3072 lds
    s_waitcnt vmcnt(0)
    ds_write_b32 v17, v16 offset:236
    s_mov_b32 s36, s24
    s_mov_b32 s37, s25
    s_mov_b32 s38, 2097152
    s_mov_b32 s39, 0x00020000
    s_add_u32 s44, s24, 20971520
    s_addc_u32 s45, s25, 0
    s_mov_b32 s46, 786432
    s_mov_b32 s47, 0x00020000
    v_mov_b32 v6, 156864
    v_lshlrev_b32 v2, 4, v1
sp_44:
    ds_read_b32 v61, v6 offset:80
    s_waitcnt lgkmcnt(0)
    v_cmp_ne_u32 vcc, 0, v61
    s_cbranch_vccnz sp_44_d
    s_sleep 1
    s_add_u32 s72, s72, 1
    s_cmp_lt_u32 s72, 0x80000
    s_cbranch_scc1 sp_44
sp_44_d:
    s_lshl_b32 s41, s82, 4
    s_add_u32 s41, s41, s83
    s_lshl_b32 s41, s41, 11
    s_add_u32 s41, s41, 262144
    s_mov_b32 s79, 0
K_x2:
    buffer_load_dwordx4 v[64:67], v2, s[44:47], s41 offen sc1
    buffer_load_dwordx4 v[68:71], v2, s[44:47], s41 offen offset:1024 sc1
    s_waitcnt vmcnt(0)
    v_xor_b32 v72, v61, v65
    v_xor_b32 v73, v61, v67
    v_xor_b32 v74, v61, v69
    v_xor_b32 v75, v61, v71
    v_or3_b32 v72, v72, v73, v74
    v_or_b32 v72, v72, v75
    v_cmp_ne_u32 vcc, 0, v72
    s_cbranch_vccz K_x3
    s_sleep 6
    s_add_u32 s79, s79, 1
    s_cmp_lt_u32 s79, 0x4000
    s_cbranch_scc1 K_x2
K_x3:
    s_setprio 3
    v_and_b32 v76, 0xffff0000, v64
    v_lshlrev_b32 v77, 16, v64
    v_and_b32 v78, 0xffff0000, v66
    v_lshlrev_b32 v79, 16, v66
    v_rcp_f32 v72, v76
    v_rcp_f32 v75, v78
    v_fma_f32 v74, -v79, v76, -v77
    v_mul_f32 v75, v75, v72
    v_and_b32 v84, 0xffff0000, v68
    v_lshlrev_b32 v85, 16, v68
    v_and_b32 v86, 0xffff0000, v70
    v_lshlrev_b32 v87, 16, v70
    v_rcp_f32 v80, v84
    v_rcp_f32 v83, v86
    v_fma_f32 v82, -v87, v84, -v85
    v_mul_f32 v83, v83, v80
    v_lshlrev_b32 v8, 3, v1
    v_add_u32 v8, 157600, v8
    v_mov_b32 v7, 1
    ds_write_b64 v8, v[74:75] offset:1024
    ds_write_b64 v8, v[82:83] offset:1536
    ds_write_b32 v6, v7 offset:144
    s_branch K_uload
K_k5:
    s_setprio 3
    s_mov_b32 s29, 0
    s_lshl_b32 s31, s28, 2
    s_load_dword s63, s[18:19], s31
    s_lshl_b32 s31, s28, 9
    v_lshlrev_b32 v2, 2, v1
    s_mov_b32 s32, s6
    s_mov_b32 s33, s7
    s_mov_b32 s34, 131072
    s_mov_b32 s35, 0x00020000
    buffer_load_dword v52, v2, s[32:35], s31 offen
    s_mov_b32 s32, s8
    s_mov_b32 s33, s9
    s_mov_b32 s34, 131072
    s_mov_b32 s35, 0x00020000
    buffer_load_dword v53, v2, s[32:35], s31 offen
    s_mov_b32 s32, s10
    s_mov_b32 s33, s11
    s_mov_b32 s34, 131072
    s_mov_b32 s35, 0x00020000
    buffer_load_dword v54, v2, s[32:35], s31 offen
    s_mov_b32 s32, s12
    s_mov_b32 s33, s13
    s_mov_b32 s34, 131072
    s_mov_b32 s35, 0x00020000
    buffer_load_dword v55, v2, s[32:35], s31 offen
    s_mov_b32 s32, s14
    s_mov_b32 s33, s15
    s_mov_b32 s34, 131072
    s_mov_b32 s35, 0x00020000
    buffer_load_dword v56, v2, s[32:35], s31 offen
    s_mov_b32 s32, s16
    s_mov_b32 s33, s17
    s_mov_b32 s34, 131072
    s_mov_b32 s35, 0x00020000
    buffer_load_dword v57, v2, s[32:35], s31 offen
    s_mov_b32 s36, s20
    s_mov_b32 s37, s21
    s_mov_b32 s38, 1835008
    s_mov_b32 s39, 0x00020000
    v_lshlrev_b32 v5, 4, v1
    s_mul_i32 s40, s2, 7168
    buffer_load_dwordx4 v[208:211], v5, s[36:39], s40 offen offset:0
    buffer_load_dwordx4 v[212:215], v5, s[36:39], s40 offen offset:1024
    buffer_load_dwordx4 v[216:219], v5, s[36:39], s40 offen offset:2048
    buffer_load_dwordx4 v[220:223], v5, s[36:39], s40 offen offset:3072
    s_add_u32 s40, s40, 4096
    buffer_load_dwordx4 v[224:227], v5, s[36:39], s40 offen offset:0
    buffer_load_dwordx4 v[228:231], v5, s[36:39], s40 offen offset:1024
    buffer_load_dwordx4 v[232:235], v5, s[36:39], s40 offen offset:2048
    s_add_u32 s40, s24, 16777216
    s_addc_u32 s41, s25, 0
    s_mov_b32 s42, 2097152
    s_mov_b32 s43, 0x00020000
    s_lshl_b32 s44, s28, 13
    v_mov_b32 v8, -1
    v_mov_b32 v9, -1
    v_mov_b32 v10, -1
    v_mov_b32 v11, -1
    buffer_store_dwordx4 v[8:11], v5, s[40:43], s44 offen offset:0 sc1
    buffer_store_dwordx4 v[8:11], v5, s[40:43], s44 offen offset:1024 sc1
    buffer_store_dwordx4 v[8:11], v5, s[40:43], s44 offen offset:2048 sc1
    buffer_store_dwordx4 v[8:11], v5, s[40:43], s44 offen offset:3072 sc1
    s_add_u32 s44, s44, 4096
    buffer_store_dwordx4 v[8:11], v5, s[40:43], s44 offen offset:0 sc1
    buffer_store_dwordx4 v[8:11], v5, s[40:43], s44 offen offset:1024 sc1
    buffer_store_dwordx4 v[8:11], v5, s[40:43], s44 offen offset:2048 sc1
    buffer_store_dwordx4 v[8:11], v5, s[40:43], s44 offen offset:3072 sc1
K_k6:
    v_mov_b32 v3, 156864
    s_mul_i32 s54, s29, 12896
    s_add_u32 s54, s54, 131072
    s_lshl_b32 s61, s29, 16
    s_add_u32 s61, s61, 28672
    s_mov_b32 s45, 32768
    v_and_b32 v5, 31, v1
    v_lshlrev_b32 v5, 7, v5
    v_lshrrev_b32 v6, 5, v1
    v_mul_u32_u24 v6, s45, v6
    v_add3_u32 v5, v5, v6, s61
    v_and_b32 v6, 7, v1
    v_xor_b32 v7, 0, v6
    v_lshl_add_u32 v244, v7, 4, v5
    v_xor_b32 v7, 1, v6
    v_lshl_add_u32 v245, v7, 4, v5
    v_xor_b32 v7, 2, v6
    v_lshl_add_u32 v246, v7, 4, v5
    v_xor_b32 v7, 3, v6
    v_lshl_add_u32 v247, v7, 4, v5
    v_xor_b32 v7, 4, v6
    v_lshl_add_u32 v248, v7, 4, v5
    v_xor_b32 v7, 5, v6
    v_lshl_add_u32 v249, v7, 4, v5
    v_xor_b32 v7, 6, v6
    v_lshl_add_u32 v250, v7, 4, v5
    v_xor_b32 v7, 7, v6
    v_lshl_add_u32 v251, v7, 4, v5
    v_bfe_u32 v5, v1, 2, 2
    v_lshrrev_b32 v6, 5, v1
    v_lshlrev_b32 v6, 2, v6
    v_lshrrev_b32 v7, 1, v5
    v_add_u32 v6, v6, v7
    v_and_b32 v5, 1, v5
    v_lshlrev_b32 v5, 2, v5
    v_bfe_u32 v7, v1, 4, 1
    v_lshl_add_u32 v5, v7, 1, v5
    v_bfe_u32 v7, v1, 1, 1
    v_add_u32 v5, v5, v7
    v_and_b32 v7, 1, v1
    v_lshlrev_b32 v7, 3, v7
    v_add_u32 v7, s61, v7
    v_xor_b32 v15, v5, v6
    v_lshl_add_u32 v15, v15, 4, v7
    v_lshl_add_u32 v252, v6, 7, v15
    v_add_u32 v18, s45, v252
    v_add_u32 v6, 2, v6
    v_xor_b32 v15, v5, v6
    v_lshl_add_u32 v15, v15, 4, v7
    v_lshl_add_u32 v253, v6, 7, v15
    v_add_u32 v19, s45, v253
    s_waitcnt lgkmcnt(0)
    s_lshl_b32 s62, s29, 4
    s_lshr_b32 s60, s63, s62
    s_lshl_b32 s60, s60, 16
    v_mov_b32 v14, 0x3fb8aa3b
    v_mul_f32 v14, s60, v14
    v_exp_f32 v14, v14
    s_nop 0
    v_cvt_pk_bf16_f32 v15, v14, v14
    v_lshlrev_b32 v14, 16, v15
    s_waitcnt vmcnt(15)
    s_setprio 1
    v_lshlrev_b32 v8, 16, v52
    v_lshlrev_b32 v9, 16, v53
    v_lshlrev_b32 v10, 16, v54
    v_lshlrev_b32 v11, 16, v55
    v_lshlrev_b32 v12, 16, v56
    v_lshlrev_b32 v13, 16, v57
    v_mul_f32 v8, v14, v8
    v_mul_f32 v9, v14, v9
    v_mul_f32 v10, v14, v10
    v_mul_f32 v11, v14, v11
    v_mul_f32 v8, 0x3fb8aa3b, v8
    v_mul_f32 v9, 0.15915494, v9
    v_mul_f32 v25, 0x40800000, v8
    v_mul_f32 v27, 0x40800000, v9
    v_mul_f32 v29, 0x3f800000, v8
    v_mul_f32 v31, 0x3f800000, v9
    v_mul_f32 v33, 0x43000000, v8
    v_mul_f32 v35, 0x43000000, v9
    v_exp_f32 v25, v25
    v_fract_f32 v27, v27
    v_exp_f32 v29, v29
    v_fract_f32 v31, v31
    v_exp_f32 v33, v33
    v_fract_f32 v35, v35
    v_cos_f32 v41, v27
    v_sin_f32 v43, v27
    v_cos_f32 v20, v31
    v_sin_f32 v22, v31
    v_cos_f32 v21, v35
    v_sin_f32 v23, v35
    v_mul_f32 v41, v25, v41
    v_mul_f32 v43, v25, v43
    v_mul_f32 v20, v29, v20
    v_mul_f32 v22, v29, v22
    v_mul_f32 v21, v33, v21
    v_mul_f32 v23, v33, v23
    v_mul_f32 v32, v41, v41
    v_mul_f32 v34, v41, v43
    v_fma_f32 v32, -v43, v43, v32
    v_fmac_f32 v34, v43, v41
    v_mul_f32 v60, v12, v10
    v_mul_f32 v62, v12, v11
    v_fma_f32 v60, -v13, v11, v60
    v_fmac_f32 v62, v13, v10
    v_mul_f32 v36, v21, v21
    v_mul_f32 v38, v21, v23
    v_fma_f32 v36, -v23, v23, v36
    v_fmac_f32 v38, v23, v21
    v_mul_f32 v24, v20, v20
    v_mul_f32 v26, v20, v22
    v_fma_f32 v24, -v22, v22, v24
    v_fmac_f32 v26, v22, v20
    v_mul_f32 v61, v60, v21
    v_mul_f32 v63, v60, v23
    v_fma_f32 v61, -v62, v23, v61
    v_fmac_f32 v63, v62, v21
    v_mul_f32 v28, v24, v20
    v_mul_f32 v30, v24, v22
    v_fma_f32 v28, -v26, v22, v28
    v_fmac_f32 v30, v26, v20
    v_mov_b32 v40, 1.0
    v_mov_b32 v42, 0
    v_cvt_pk_bf16_f32 v112, v40, v41
    v_cvt_pk_bf16_f32 v128, v42, v43
    v_pk_mul_f32 v[44:45], v[40:41], v[32:33] op_sel_hi:[1,0]
    v_pk_mul_f32 v[46:47], v[40:41], v[34:35] op_sel_hi:[1,0]
    v_pk_mul_f32 v[64:65], v[60:61], v[36:37] op_sel_hi:[1,0]
    v_pk_mul_f32 v[66:67], v[60:61], v[38:39] op_sel_hi:[1,0]
    v_pk_fma_f32 v[44:45], v[42:43], v[34:35], v[44:45] op_sel_hi:[1,0,1] neg_lo:[0,1,0] neg_hi:[0,1,0]
    v_pk_fma_f32 v[46:47], v[42:43], v[32:33], v[46:47] op_sel_hi:[1,0,1]
    v_pk_fma_f32 v[64:65], v[62:63], v[38:39], v[64:65] op_sel_hi:[1,0,1] neg_lo:[0,1,0] neg_hi:[0,1,0]
    v_pk_fma_f32 v[66:67], v[62:63], v[36:37], v[66:67] op_sel_hi:[1,0,1]
    v_cvt_pk_bf16_f32 v113, v44, v45
    v_cvt_pk_bf16_f32 v129, v46, v47
    v_pk_mul_f32 v[40:41], v[44:45], v[32:33] op_sel_hi:[1,0]
    v_pk_mul_f32 v[42:43], v[44:45], v[34:35] op_sel_hi:[1,0]
    v_pk_mul_f32 v[68:69], v[64:65], v[36:37] op_sel_hi:[1,0]
    v_pk_mul_f32 v[70:71], v[64:65], v[38:39] op_sel_hi:[1,0]
    v_pk_fma_f32 v[40:41], v[46:47], v[34:35], v[40:41] op_sel_hi:[1,0,1] neg_lo:[0,1,0] neg_hi:[0,1,0]
    v_pk_fma_f32 v[42:43], v[46:47], v[32:33], v[42:43] op_sel_hi:[1,0,1]
    v_pk_fma_f32 v[68:69], v[66:67], v[38:39], v[68:69] op_sel_hi:[1,0,1] neg_lo:[0,1,0] neg_hi:[0,1,0]
    v_pk_fma_f32 v[70:71], v[66:67], v[36:37], v[70:71] op_sel_hi:[1,0,1]
    v_cvt_pk_bf16_f32 v114, v40, v41
    v_cvt_pk_bf16_f32 v130, v42, v43
    v_pk_mul_f32 v[44:45], v[40:41], v[32:33] op_sel_hi:[1,0]
    v_pk_mul_f32 v[46:47], v[40:41], v[34:35] op_sel_hi:[1,0]
    v_pk_mul_f32 v[72:73], v[68:69], v[36:37] op_sel_hi:[1,0]
    v_pk_mul_f32 v[74:75], v[68:69], v[38:39] op_sel_hi:[1,0]
    v_pk_fma_f32 v[44:45], v[42:43], v[34:35], v[44:45] op_sel_hi:[1,0,1] neg_lo:[0,1,0] neg_hi:[0,1,0]
    v_pk_fma_f32 v[46:47], v[42:43], v[32:33], v[46:47] op_sel_hi:[1,0,1]
    v_pk_fma_f32 v[72:73], v[70:71], v[38:39], v[72:73] op_sel_hi:[1,0,1] neg_lo:[0,1,0] neg_hi:[0,1,0]
    v_pk_fma_f32 v[74:75], v[70:71], v[36:37], v[74:75] op_sel_hi:[1,0,1]
    v_cvt_pk_bf16_f32 v115, v44, v45
    v_cvt_pk_bf16_f32 v131, v46, v47
    v_pk_mul_f32 v[40:41], v[44:45], v[32:33] op_sel_hi:[1,0]
    v_pk_mul_f32 v[42:43], v[44:45], v[34:35] op_sel_hi:[1,0]
    v_pk_mul_f32 v[76:77], v[72:73], v[36:37] op_sel_hi:[1,0]
    v_pk_mul_f32 v[78:79], v[72:73], v[38:39] op_sel_hi:[1,0]
    v_pk_fma_f32 v[40:41], v[46:47], v[34:35], v[40:41] op_sel_hi:[1,0,1] neg_lo:[0,1,0] neg_hi:[0,1,0]
    v_pk_fma_f32 v[42:43], v[46:47], v[32:33], v[42:43] op_sel_hi:[1,0,1]
    v_pk_fma_f32 v[76:77], v[74:75], v[38:39], v[76:77] op_sel_hi:[1,0,1] neg_lo:[0,1,0] neg_hi:[0,1,0]
    v_pk_fma_f32 v[78:79], v[74:75], v[36:37], v[78:79] op_sel_hi:[1,0,1]
    v_cvt_pk_bf16_f32 v116, v40, v41
    v_cvt_pk_bf16_f32 v132, v42, v43
    v_pk_mul_f32 v[44:45], v[40:41], v[32:33] op_sel_hi:[1,0]
    v_pk_mul_f32 v[46:47], v[40:41], v[34:35] op_sel_hi:[1,0]
    v_pk_mul_f32 v[80:81], v[76:77], v[36:37] op_sel_hi:[1,0]
    v_pk_mul_f32 v[82:83], v[76:77], v[38:39] op_sel_hi:[1,0]
    v_pk_fma_f32 v[44:45], v[42:43], v[34:35], v[44:45] op_sel_hi:[1,0,1] neg_lo:[0,1,0] neg_hi:[0,1,0]
    v_pk_fma_f32 v[46:47], v[42:43], v[32:33], v[46:47] op_sel_hi:[1,0,1]
    v_pk_fma_f32 v[80:81], v[78:79], v[38:39], v[80:81] op_sel_hi:[1,0,1] neg_lo:[0,1,0] neg_hi:[0,1,0]
    v_pk_fma_f32 v[82:83], v[78:79], v[36:37], v[82:83] op_sel_hi:[1,0,1]
    v_cvt_pk_bf16_f32 v117, v44, v45
    v_cvt_pk_bf16_f32 v133, v46, v47
    v_pk_mul_f32 v[40:41], v[44:45], v[32:33] op_sel_hi:[1,0]
    v_pk_mul_f32 v[42:43], v[44:45], v[34:35] op_sel_hi:[1,0]
    v_pk_mul_f32 v[84:85], v[80:81], v[36:37] op_sel_hi:[1,0]
    v_pk_mul_f32 v[86:87], v[80:81], v[38:39] op_sel_hi:[1,0]
    v_pk_fma_f32 v[40:41], v[46:47], v[34:35], v[40:41] op_sel_hi:[1,0,1] neg_lo:[0,1,0] neg_hi:[0,1,0]
    v_pk_fma_f32 v[42:43], v[46:47], v[32:33], v[42:43] op_sel_hi:[1,0,1]
    v_pk_fma_f32 v[84:85], v[82:83], v[38:39], v[84:85] op_sel_hi:[1,0,1] neg_lo:[0,1,0] neg_hi:[0,1,0]
    v_pk_fma_f32 v[86:87], v[82:83], v[36:37], v[86:87] op_sel_hi:[1,0,1]
    v_cvt_pk_bf16_f32 v118, v40, v41
    v_cvt_pk_bf16_f32 v134, v42, v43
    v_pk_mul_f32 v[44:45], v[40:41], v[32:33] op_sel_hi:[1,0]
    v_pk_mul_f32 v[46:47], v[40:41], v[34:35] op_sel_hi:[1,0]
    v_pk_mul_f32 v[88:89], v[84:85], v[36:37] op_sel_hi:[1,0]
    v_pk_mul_f32 v[90:91], v[84:85], v[38:39] op_sel_hi:[1,0]
    v_pk_fma_f32 v[44:45], v[42:43], v[34:35], v[44:45] op_sel_hi:[1,0,1] neg_lo:[0,1,0] neg_hi:[0,1,0]
    v_pk_fma_f32 v[46:47], v[42:43], v[32:33], v[46:47] op_sel_hi:[1,0,1]
    v_pk_fma_f32 v[88:89], v[86:87], v[38:39], v[88:89] op_sel_hi:[1,0,1] neg_lo:[0,1,0] neg_hi:[0,1,0]
    v_pk_fma_f32 v[90:91], v[86:87], v[36:37], v[90:91] op_sel_hi:[1,0,1]
    v_cvt_pk_bf16_f32 v119, v44, v45
    v_cvt_pk_bf16_f32 v135, v46, v47
    v_pk_mul_f32 v[40:41], v[44:45], v[32:33] op_sel_hi:[1,0]
    v_pk_mul_f32 v[42:43], v[44:45], v[34:35] op_sel_hi:[1,0]
    v_pk_mul_f32 v[92:93], v[88:89], v[36:37] op_sel_hi:[1,0]
    v_pk_mul_f32 v[94:95], v[88:89], v[38:39] op_sel_hi:[1,0]
    v_pk_fma_f32 v[40:41], v[46:47], v[34:35], v[40:41] op_sel_hi:[1,0,1] neg_lo:[0,1,0] neg_hi:[0,1,0]
    v_pk_fma_f32 v[42:43], v[46:47], v[32:33], v[42:43] op_sel_hi:[1,0,1]
    v_pk_fma_f32 v[92:93], v[90:91], v[38:39], v[92:93] op_sel_hi:[1,0,1] neg_lo:[0,1,0] neg_hi:[0,1,0]
    v_pk_fma_f32 v[94:95], v[90:91], v[36:37], v[94:95] op_sel_hi:[1,0,1]
    v_cvt_pk_bf16_f32 v120, v40, v41
    v_cvt_pk_bf16_f32 v136, v42, v43
    v_pk_mul_f32 v[44:45], v[40:41], v[32:33] op_sel_hi:[1,0]
    v_pk_mul_f32 v[46:47], v[40:41], v[34:35] op_sel_hi:[1,0]
    v_pk_mul_f32 v[96:97], v[60:61], v[20:21] op_sel_hi:[1,0]
    v_pk_mul_f32 v[98:99], v[60:61], v[22:23] op_sel_hi:[1,0]
    v_pk_fma_f32 v[44:45], v[42:43], v[34:35], v[44:45] op_sel_hi:[1,0,1] neg_lo:[0,1,0] neg_hi:[0,1,0]
    v_pk_fma_f32 v[46:47], v[42:43], v[32:33], v[46:47] op_sel_hi:[1,0,1]
    v_pk_fma_f32 v[96:97], v[62:63], v[22:23], v[96:97] op_sel_hi:[1,0,1] neg_lo:[0,1,0] neg_hi:[0,1,0]
    v_pk_fma_f32 v[98:99], v[62:63], v[20:21], v[98:99] op_sel_hi:[1,0,1]
    v_cvt_pk_bf16_f32 v121, v44, v45
    v_cvt_pk_bf16_f32 v137, v46, v47
    v_pk_mul_f32 v[40:41], v[44:45], v[32:33] op_sel_hi:[1,0]
    v_pk_mul_f32 v[42:43], v[44:45], v[34:35] op_sel_hi:[1,0]
    v_pk_mul_f32 v[100:101], v[60:61], v[24:25] op_sel_hi:[1,0]
    v_pk_mul_f32 v[102:103], v[60:61], v[26:27] op_sel_hi:[1,0]
    v_pk_fma_f32 v[40:41], v[46:47], v[34:35], v[40:41] op_sel_hi:[1,0,1] neg_lo:[0,1,0] neg_hi:[0,1,0]
    v_pk_fma_f32 v[42:43], v[46:47], v[32:33], v[42:43] op_sel_hi:[1,0,1]
    v_pk_fma_f32 v[100:101], v[62:63], v[26:27], v[100:101] op_sel_hi:[1,0,1] neg_lo:[0,1,0] neg_hi:[0,1,0]
    v_pk_fma_f32 v[102:103], v[62:63], v[24:25], v[102:103] op_sel_hi:[1,0,1]
    v_cvt_pk_bf16_f32 v122, v40, v41
    v_cvt_pk_bf16_f32 v138, v42, v43
    v_pk_mul_f32 v[44:45], v[40:41], v[32:33] op_sel_hi:[1,0]
    v_pk_mul_f32 v[46:47], v[40:41], v[34:35] op_sel_hi:[1,0]
    v_pk_mul_f32 v[104:105], v[60:61], v[28:29] op_sel_hi:[1,0]
    v_pk_mul_f32 v[106:107], v[60:61], v[30:31] op_sel_hi:[1,0]
    v_pk_fma_f32 v[44:45], v[42:43], v[34:35], v[44:45] op_sel_hi:[1,0,1] neg_lo:[0,1,0] neg_hi:[0,1,0]
    v_pk_fma_f32 v[46:47], v[42:43], v[32:33], v[46:47] op_sel_hi:[1,0,1]
    v_pk_fma_f32 v[104:105], v[62:63], v[30:31], v[104:105] op_sel_hi:[1,0,1] neg_lo:[0,1,0] neg_hi:[0,1,0]
    v_pk_fma_f32 v[106:107], v[62:63], v[28:29], v[106:107] op_sel_hi:[1,0,1]
    v_cvt_pk_bf16_f32 v123, v44, v45
    v_cvt_pk_bf16_f32 v139, v46, v47
    v_pk_mul_f32 v[40:41], v[44:45], v[32:33] op_sel_hi:[1,0]
    v_pk_mul_f32 v[42:43], v[44:45], v[34:35] op_sel_hi:[1,0]
    v_pk_mul_f32 v[108:109], v[64:65], v[24:25] op_sel_hi:[1,0]
    v_pk_mul_f32 v[110:111], v[64:65], v[26:27] op_sel_hi:[1,0]
    v_pk_fma_f32 v[40:41], v[46:47], v[34:35], v[40:41] op_sel_hi:[1,0,1] neg_lo:[0,1,0] neg_hi:[0,1,0]
    v_pk_fma_f32 v[42:43], v[46:47], v[32:33], v[42:43] op_sel_hi:[1,0,1]
    v_pk_fma_f32 v[108:109], v[66:67], v[26:27], v[108:109] op_sel_hi:[1,0,1] neg_lo:[0,1,0] neg_hi:[0,1,0]
    v_pk_fma_f32 v[110:111], v[66:67], v[24:25], v[110:111] op_sel_hi:[1,0,1]
    v_cvt_pk_bf16_f32 v124, v40, v41
    v_cvt_pk_bf16_f32 v140, v42, v43
    v_pk_mul_f32 v[44:45], v[40:41], v[32:33] op_sel_hi:[1,0]
    v_pk_mul_f32 v[46:47], v[40:41], v[34:35] op_sel_hi:[1,0]
    v_pk_fma_f32 v[44:45], v[42:43], v[34:35], v[44:45] op_sel_hi:[1,0,1] neg_lo:[0,1,0] neg_hi:[0,1,0]
    v_pk_fma_f32 v[46:47], v[42:43], v[32:33], v[46:47] op_sel_hi:[1,0,1]
    v_cvt_pk_bf16_f32 v125, v44, v45
    v_cvt_pk_bf16_f32 v141, v46, v47
    v_pk_mul_f32 v[40:41], v[44:45], v[32:33] op_sel_hi:[1,0]
    v_pk_mul_f32 v[42:43], v[44:45], v[34:35] op_sel_hi:[1,0]
    v_pk_fma_f32 v[40:41], v[46:47], v[34:35], v[40:41] op_sel_hi:[1,0,1] neg_lo:[0,1,0] neg_hi:[0,1,0]
    v_pk_fma_f32 v[42:43], v[46:47], v[32:33], v[42:43] op_sel_hi:[1,0,1]
    v_cvt_pk_bf16_f32 v126, v40, v41
    v_cvt_pk_bf16_f32 v142, v42, v43
    v_pk_mul_f32 v[44:45], v[40:41], v[32:33] op_sel_hi:[1,0]
    v_pk_mul_f32 v[46:47], v[40:41], v[34:35] op_sel_hi:[1,0]
    v_pk_fma_f32 v[44:45], v[42:43], v[34:35], v[44:45] op_sel_hi:[1,0,1] neg_lo:[0,1,0] neg_hi:[0,1,0]
    v_pk_fma_f32 v[46:47], v[42:43], v[32:33], v[46:47] op_sel_hi:[1,0,1]
    v_cvt_pk_bf16_f32 v127, v44, v45
    v_cvt_pk_bf16_f32 v143, v46, v47
    v_cvt_pk_bf16_f32 v144, v60, v96
    v_cvt_pk_bf16_f32 v160, -v62, -v98
    v_cvt_pk_bf16_f32 v145, v100, v104
    v_cvt_pk_bf16_f32 v161, -v102, -v106
    v_cvt_pk_bf16_f32 v146, v61, v97
    v_cvt_pk_bf16_f32 v162, -v63, -v99
    v_cvt_pk_bf16_f32 v147, v101, v105
    v_cvt_pk_bf16_f32 v163, -v103, -v107
    v_cvt_pk_bf16_f32 v148, v64, v108
    v_cvt_pk_bf16_f32 v164, -v66, -v110
    v_cvt_pk_bf16_f32 v149, v68, v72
    v_cvt_pk_bf16_f32 v165, -v70, -v74
    v_cvt_pk_bf16_f32 v150, v65, v109
    v_cvt_pk_bf16_f32 v166, -v67, -v111
    v_cvt_pk_bf16_f32 v151, v69, v73
    v_cvt_pk_bf16_f32 v167, -v71, -v75
    v_cvt_pk_bf16_f32 v152, v76, v80
    v_cvt_pk_bf16_f32 v168, -v78, -v82
    v_cvt_pk_bf16_f32 v153, v84, v88
    v_cvt_pk_bf16_f32 v169, -v86, -v90
    v_cvt_pk_bf16_f32 v154, v77, v81
    v_cvt_pk_bf16_f32 v170, -v79, -v83
    v_cvt_pk_bf16_f32 v155, v85, v89
    v_cvt_pk_bf16_f32 v171, -v87, -v91
    v_cvt_pk_bf16_f32 v156, v92, v92
    v_cvt_pk_bf16_f32 v172, -v94, -v94
    v_and_b32 v8, 0xffff0000, v52
    v_and_b32 v9, 0xffff0000, v53
    v_and_b32 v10, 0xffff0000, v54
    v_and_b32 v11, 0xffff0000, v55
    v_and_b32 v12, 0xffff0000, v56
    v_and_b32 v13, 0xffff0000, v57
    v_mul_f32 v8, v14, v8
    v_mul_f32 v9, v14, v9
    v_mul_f32 v10, v14, v10
    v_mul_f32 v11, v14, v11
    v_mul_f32 v8, 0x3fb8aa3b, v8
    v_mul_f32 v9, 0.15915494, v9
    v_mul_f32 v25, 0x40800000, v8
    v_mul_f32 v27, 0x40800000, v9
    v_mul_f32 v29, 0x3f800000, v8
    v_mul_f32 v31, 0x3f800000, v9
    v_mul_f32 v33, 0x43000000, v8
    v_mul_f32 v35, 0x43000000, v9
    v_exp_f32 v25, v25
    v_fract_f32 v27, v27
    v_exp_f32 v29, v29
    v_fract_f32 v31, v31
    v_exp_f32 v33, v33
    v_fract_f32 v35, v35
    v_cos_f32 v41, v27
    v_sin_f32 v43, v27
    v_cos_f32 v20, v31
    v_sin_f32 v22, v31
    v_cos_f32 v21, v35
    v_sin_f32 v23, v35
    v_mul_f32 v41, v25, v41
    v_mul_f32 v43, v25, v43
    v_mul_f32 v20, v29, v20
    v_mul_f32 v22, v29, v22
    v_mul_f32 v21, v33, v21
    v_mul_f32 v23, v33, v23
    v_mul_f32 v32, v41, v41
    v_mul_f32 v34, v41, v43
    v_fma_f32 v32, -v43, v43, v32
    v_fmac_f32 v34, v43, v41
    v_mul_f32 v60, v12, v10
    v_mul_f32 v62, v12, v11
    v_fma_f32 v60, -v13, v11, v60
    v_fmac_f32 v62, v13, v10
    v_mul_f32 v36, v21, v21
    v_mul_f32 v38, v21, v23
    v_fma_f32 v36, -v23, v23, v36
    v_fmac_f32 v38, v23, v21
    v_mul_f32 v24, v20, v20
    v_mul_f32 v26, v20, v22
    v_fma_f32 v24, -v22, v22, v24
    v_fmac_f32 v26, v22, v20
    v_mul_f32 v61, v60, v21
    v_mul_f32 v63, v60, v23
    v_fma_f32 v61, -v62, v23, v61
    v_fmac_f32 v63, v62, v21
    v_mul_f32 v28, v24, v20
    v_mul_f32 v30, v24, v22
    v_fma_f32 v28, -v26, v22, v28
    v_fmac_f32 v30, v26, v20
    v_mov_b32 v40, 1.0
    v_mov_b32 v42, 0
    s_waitcnt vmcnt(0)
    v_mov_b32 v4, 1
    s_lshl_b32 s44, s29, 2
    v_add_u32 v5, s44, v3
    ds_write_b32 v5, v4 offset:240
    v_cvt_pk_bf16_f32 v176, v40, v41
    v_cvt_pk_bf16_f32 v192, v42, v43
    v_pk_mul_f32 v[44:45], v[40:41], v[32:33] op_sel_hi:[1,0]
    v_pk_mul_f32 v[46:47], v[40:41], v[34:35] op_sel_hi:[1,0]
    v_pk_mul_f32 v[64:65], v[60:61], v[36:37] op_sel_hi:[1,0]
    v_pk_mul_f32 v[66:67], v[60:61], v[38:39] op_sel_hi:[1,0]
    v_pk_fma_f32 v[44:45], v[42:43], v[34:35], v[44:45] op_sel_hi:[1,0,1] neg_lo:[0,1,0] neg_hi:[0,1,0]
    v_pk_fma_f32 v[46:47], v[42:43], v[32:33], v[46:47] op_sel_hi:[1,0,1]
    v_pk_fma_f32 v[64:65], v[62:63], v[38:39], v[64:65] op_sel_hi:[1,0,1] neg_lo:[0,1,0] neg_hi:[0,1,0]
    v_pk_fma_f32 v[66:67], v[62:63], v[36:37], v[66:67] op_sel_hi:[1,0,1]
    v_cvt_pk_bf16_f32 v177, v44, v45
    v_cvt_pk_bf16_f32 v193, v46, v47
    v_pk_mul_f32 v[40:41], v[44:45], v[32:33] op_sel_hi:[1,0]
    v_pk_mul_f32 v[42:43], v[44:45], v[34:35] op_sel_hi:[1,0]
    v_pk_mul_f32 v[68:69], v[64:65], v[36:37] op_sel_hi:[1,0]
    v_pk_mul_f32 v[70:71], v[64:65], v[38:39] op_sel_hi:[1,0]
    v_pk_fma_f32 v[40:41], v[46:47], v[34:35], v[40:41] op_sel_hi:[1,0,1] neg_lo:[0,1,0] neg_hi:[0,1,0]
    v_pk_fma_f32 v[42:43], v[46:47], v[32:33], v[42:43] op_sel_hi:[1,0,1]
    v_pk_fma_f32 v[68:69], v[66:67], v[38:39], v[68:69] op_sel_hi:[1,0,1] neg_lo:[0,1,0] neg_hi:[0,1,0]
    v_pk_fma_f32 v[70:71], v[66:67], v[36:37], v[70:71] op_sel_hi:[1,0,1]
    v_cvt_pk_bf16_f32 v178, v40, v41
    v_cvt_pk_bf16_f32 v194, v42, v43
    v_pk_mul_f32 v[44:45], v[40:41], v[32:33] op_sel_hi:[1,0]
    v_pk_mul_f32 v[46:47], v[40:41], v[34:35] op_sel_hi:[1,0]
    v_pk_mul_f32 v[72:73], v[68:69], v[36:37] op_sel_hi:[1,0]
    v_pk_mul_f32 v[74:75], v[68:69], v[38:39] op_sel_hi:[1,0]
    v_pk_fma_f32 v[44:45], v[42:43], v[34:35], v[44:45] op_sel_hi:[1,0,1] neg_lo:[0,1,0] neg_hi:[0,1,0]
    v_pk_fma_f32 v[46:47], v[42:43], v[32:33], v[46:47] op_sel_hi:[1,0,1]
    v_pk_fma_f32 v[72:73], v[70:71], v[38:39], v[72:73] op_sel_hi:[1,0,1] neg_lo:[0,1,0] neg_hi:[0,1,0]
    v_pk_fma_f32 v[74:75], v[70:71], v[36:37], v[74:75] op_sel_hi:[1,0,1]
    v_cvt_pk_bf16_f32 v179, v44, v45
    v_cvt_pk_bf16_f32 v195, v46, v47
    v_pk_mul_f32 v[40:41], v[44:45], v[32:33] op_sel_hi:[1,0]
    v_pk_mul_f32 v[42:43], v[44:45], v[34:35] op_sel_hi:[1,0]
    v_pk_mul_f32 v[76:77], v[72:73], v[36:37] op_sel_hi:[1,0]
    v_pk_mul_f32 v[78:79], v[72:73], v[38:39] op_sel_hi:[1,0]
    v_pk_fma_f32 v[40:41], v[46:47], v[34:35], v[40:41] op_sel_hi:[1,0,1] neg_lo:[0,1,0] neg_hi:[0,1,0]
    v_pk_fma_f32 v[42:43], v[46:47], v[32:33], v[42:43] op_sel_hi:[1,0,1]
    v_pk_fma_f32 v[76:77], v[74:75], v[38:39], v[76:77] op_sel_hi:[1,0,1] neg_lo:[0,1,0] neg_hi:[0,1,0]
    v_pk_fma_f32 v[78:79], v[74:75], v[36:37], v[78:79] op_sel_hi:[1,0,1]
    v_cvt_pk_bf16_f32 v180, v40, v41
    v_cvt_pk_bf16_f32 v196, v42, v43
    v_pk_mul_f32 v[44:45], v[40:41], v[32:33] op_sel_hi:[1,0]
    v_pk_mul_f32 v[46:47], v[40:41], v[34:35] op_sel_hi:[1,0]
    v_pk_mul_f32 v[80:81], v[76:77], v[36:37] op_sel_hi:[1,0]
    v_pk_mul_f32 v[82:83], v[76:77], v[38:39] op_sel_hi:[1,0]
    v_pk_fma_f32 v[44:45], v[42:43], v[34:35], v[44:45] op_sel_hi:[1,0,1] neg_lo:[0,1,0] neg_hi:[0,1,0]
    v_pk_fma_f32 v[46:47], v[42:43], v[32:33], v[46:47] op_sel_hi:[1,0,1]
    v_pk_fma_f32 v[80:81], v[78:79], v[38:39], v[80:81] op_sel_hi:[1,0,1] neg_lo:[0,1,0] neg_hi:[0,1,0]
    v_pk_fma_f32 v[82:83], v[78:79], v[36:37], v[82:83] op_sel_hi:[1,0,1]
    v_cvt_pk_bf16_f32 v181, v44, v45
    v_cvt_pk_bf16_f32 v197, v46, v47
    v_pk_mul_f32 v[40:41], v[44:45], v[32:33] op_sel_hi:[1,0]
    v_pk_mul_f32 v[42:43], v[44:45], v[34:35] op_sel_hi:[1,0]
    v_pk_mul_f32 v[84:85], v[80:81], v[36:37] op_sel_hi:[1,0]
    v_pk_mul_f32 v[86:87], v[80:81], v[38:39] op_sel_hi:[1,0]
    v_pk_fma_f32 v[40:41], v[46:47], v[34:35], v[40:41] op_sel_hi:[1,0,1] neg_lo:[0,1,0] neg_hi:[0,1,0]
    v_pk_fma_f32 v[42:43], v[46:47], v[32:33], v[42:43] op_sel_hi:[1,0,1]
    v_pk_fma_f32 v[84:85], v[82:83], v[38:39], v[84:85] op_sel_hi:[1,0,1] neg_lo:[0,1,0] neg_hi:[0,1,0]
    v_pk_fma_f32 v[86:87], v[82:83], v[36:37], v[86:87] op_sel_hi:[1,0,1]
    v_cvt_pk_bf16_f32 v182, v40, v41
    v_cvt_pk_bf16_f32 v198, v42, v43
    v_pk_mul_f32 v[44:45], v[40:41], v[32:33] op_sel_hi:[1,0]
    v_pk_mul_f32 v[46:47], v[40:41], v[34:35] op_sel_hi:[1,0]
    v_pk_mul_f32 v[88:89], v[84:85], v[36:37] op_sel_hi:[1,0]
    v_pk_mul_f32 v[90:91], v[84:85], v[38:39] op_sel_hi:[1,0]
    v_pk_fma_f32 v[44:45], v[42:43], v[34:35], v[44:45] op_sel_hi:[1,0,1] neg_lo:[0,1,0] neg_hi:[0,1,0]
    v_pk_fma_f32 v[46:47], v[42:43], v[32:33], v[46:47] op_sel_hi:[1,0,1]
    v_pk_fma_f32 v[88:89], v[86:87], v[38:39], v[88:89] op_sel_hi:[1,0,1] neg_lo:[0,1,0] neg_hi:[0,1,0]
    v_pk_fma_f32 v[90:91], v[86:87], v[36:37], v[90:91] op_sel_hi:[1,0,1]
    v_cvt_pk_bf16_f32 v183, v44, v45
    v_cvt_pk_bf16_f32 v199, v46, v47
    v_pk_mul_f32 v[40:41], v[44:45], v[32:33] op_sel_hi:[1,0]
    v_pk_mul_f32 v[42:43], v[44:45], v[34:35] op_sel_hi:[1,0]
    v_pk_mul_f32 v[92:93], v[88:89], v[36:37] op_sel_hi:[1,0]
    v_pk_mul_f32 v[94:95], v[88:89], v[38:39] op_sel_hi:[1,0]
    v_pk_fma_f32 v[40:41], v[46:47], v[34:35], v[40:41] op_sel_hi:[1,0,1] neg_lo:[0,1,0] neg_hi:[0,1,0]
    v_pk_fma_f32 v[42:43], v[46:47], v[32:33], v[42:43] op_sel_hi:[1,0,1]
    v_pk_fma_f32 v[92:93], v[90:91], v[38:39], v[92:93] op_sel_hi:[1,0,1] neg_lo:[0,1,0] neg_hi:[0,1,0]
    v_pk_fma_f32 v[94:95], v[90:91], v[36:37], v[94:95] op_sel_hi:[1,0,1]
    v_cvt_pk_bf16_f32 v184, v40, v41
    v_cvt_pk_bf16_f32 v200, v42, v43
    v_pk_mul_f32 v[44:45], v[40:41], v[32:33] op_sel_hi:[1,0]
    v_pk_mul_f32 v[46:47], v[40:41], v[34:35] op_sel_hi:[1,0]
    v_pk_mul_f32 v[96:97], v[60:61], v[20:21] op_sel_hi:[1,0]
    v_pk_mul_f32 v[98:99], v[60:61], v[22:23] op_sel_hi:[1,0]
    v_pk_fma_f32 v[44:45], v[42:43], v[34:35], v[44:45] op_sel_hi:[1,0,1] neg_lo:[0,1,0] neg_hi:[0,1,0]
    v_pk_fma_f32 v[46:47], v[42:43], v[32:33], v[46:47] op_sel_hi:[1,0,1]
    v_pk_fma_f32 v[96:97], v[62:63], v[22:23], v[96:97] op_sel_hi:[1,0,1] neg_lo:[0,1,0] neg_hi:[0,1,0]
    v_pk_fma_f32 v[98:99], v[62:63], v[20:21], v[98:99] op_sel_hi:[1,0,1]
    v_cvt_pk_bf16_f32 v185, v44, v45
    v_cvt_pk_bf16_f32 v201, v46, v47
    v_pk_mul_f32 v[40:41], v[44:45], v[32:33] op_sel_hi:[1,0]
    v_pk_mul_f32 v[42:43], v[44:45], v[34:35] op_sel_hi:[1,0]
    v_pk_mul_f32 v[100:101], v[60:61], v[24:25] op_sel_hi:[1,0]
    v_pk_mul_f32 v[102:103], v[60:61], v[26:27] op_sel_hi:[1,0]
    v_pk_fma_f32 v[40:41], v[46:47], v[34:35], v[40:41] op_sel_hi:[1,0,1] neg_lo:[0,1,0] neg_hi:[0,1,0]
    v_pk_fma_f32 v[42:43], v[46:47], v[32:33], v[42:43] op_sel_hi:[1,0,1]
    v_pk_fma_f32 v[100:101], v[62:63], v[26:27], v[100:101] op_sel_hi:[1,0,1] neg_lo:[0,1,0] neg_hi:[0,1,0]
    v_pk_fma_f32 v[102:103], v[62:63], v[24:25], v[102:103] op_sel_hi:[1,0,1]
    v_cvt_pk_bf16_f32 v186, v40, v41
    v_cvt_pk_bf16_f32 v202, v42, v43
    v_pk_mul_f32 v[44:45], v[40:41], v[32:33] op_sel_hi:[1,0]
    v_pk_mul_f32 v[46:47], v[40:41], v[34:35] op_sel_hi:[1,0]
    v_pk_mul_f32 v[104:105], v[60:61], v[28:29] op_sel_hi:[1,0]
    v_pk_mul_f32 v[106:107], v[60:61], v[30:31] op_sel_hi:[1,0]
    v_pk_fma_f32 v[44:45], v[42:43], v[34:35], v[44:45] op_sel_hi:[1,0,1] neg_lo:[0,1,0] neg_hi:[0,1,0]
    v_pk_fma_f32 v[46:47], v[42:43], v[32:33], v[46:47] op_sel_hi:[1,0,1]
    v_pk_fma_f32 v[104:105], v[62:63], v[30:31], v[104:105] op_sel_hi:[1,0,1] neg_lo:[0,1,0] neg_hi:[0,1,0]
    v_pk_fma_f32 v[106:107], v[62:63], v[28:29], v[106:107] op_sel_hi:[1,0,1]
    v_cvt_pk_bf16_f32 v187, v44, v45
    v_cvt_pk_bf16_f32 v203, v46, v47
    v_pk_mul_f32 v[40:41], v[44:45], v[32:33] op_sel_hi:[1,0]
    v_pk_mul_f32 v[42:43], v[44:45], v[34:35] op_sel_hi:[1,0]
    v_pk_mul_f32 v[108:109], v[64:65], v[24:25] op_sel_hi:[1,0]
    v_pk_mul_f32 v[110:111], v[64:65], v[26:27] op_sel_hi:[1,0]
    v_pk_fma_f32 v[40:41], v[46:47], v[34:35], v[40:41] op_sel_hi:[1,0,1] neg_lo:[0,1,0] neg_hi:[0,1,0]
    v_pk_fma_f32 v[42:43], v[46:47], v[32:33], v[42:43] op_sel_hi:[1,0,1]
    v_pk_fma_f32 v[108:109], v[66:67], v[26:27], v[108:109] op_sel_hi:[1,0,1] neg_lo:[0,1,0] neg_hi:[0,1,0]
    v_pk_fma_f32 v[110:111], v[66:67], v[24:25], v[110:111] op_sel_hi:[1,0,1]
    v_cvt_pk_bf16_f32 v188, v40, v41
    v_cvt_pk_bf16_f32 v204, v42, v43
    v_pk_mul_f32 v[44:45], v[40:41], v[32:33] op_sel_hi:[1,0]
    v_pk_mul_f32 v[46:47], v[40:41], v[34:35] op_sel_hi:[1,0]
    v_pk_fma_f32 v[44:45], v[42:43], v[34:35], v[44:45] op_sel_hi:[1,0,1] neg_lo:[0,1,0] neg_hi:[0,1,0]
    v_pk_fma_f32 v[46:47], v[42:43], v[32:33], v[46:47] op_sel_hi:[1,0,1]
    v_cvt_pk_bf16_f32 v189, v44, v45
    v_cvt_pk_bf16_f32 v205, v46, v47
    v_pk_mul_f32 v[40:41], v[44:45], v[32:33] op_sel_hi:[1,0]
    v_pk_mul_f32 v[42:43], v[44:45], v[34:35] op_sel_hi:[1,0]
    v_pk_fma_f32 v[40:41], v[46:47], v[34:35], v[40:41] op_sel_hi:[1,0,1] neg_lo:[0,1,0] neg_hi:[0,1,0]
    v_pk_fma_f32 v[42:43], v[46:47], v[32:33], v[42:43] op_sel_hi:[1,0,1]
    v_cvt_pk_bf16_f32 v190, v40, v41
    v_cvt_pk_bf16_f32 v206, v42, v43
    v_pk_mul_f32 v[44:45], v[40:41], v[32:33] op_sel_hi:[1,0]
    v_pk_mul_f32 v[46:47], v[40:41], v[34:35] op_sel_hi:[1,0]
    v_pk_fma_f32 v[44:45], v[42:43], v[34:35], v[44:45] op_sel_hi:[1,0,1] neg_lo:[0,1,0] neg_hi:[0,1,0]
    v_pk_fma_f32 v[46:47], v[42:43], v[32:33], v[46:47] op_sel_hi:[1,0,1]
    v_cvt_pk_bf16_f32 v191, v44, v45
    v_cvt_pk_bf16_f32 v207, v46, v47
    v_cvt_pk_bf16_f32 v208, v60, v96
    v_cvt_pk_bf16_f32 v224, -v62, -v98
    v_cvt_pk_bf16_f32 v209, v100, v104
    v_cvt_pk_bf16_f32 v225, -v102, -v106
    v_cvt_pk_bf16_f32 v210, v61, v97
    v_cvt_pk_bf16_f32 v226, -v63, -v99
    v_cvt_pk_bf16_f32 v211, v101, v105
    v_cvt_pk_bf16_f32 v227, -v103, -v107
    v_cvt_pk_bf16_f32 v212, v64, v108
    v_cvt_pk_bf16_f32 v228, -v66, -v110
    v_cvt_pk_bf16_f32 v213, v68, v72
    v_cvt_pk_bf16_f32 v229, -v70, -v74
    v_cvt_pk_bf16_f32 v214, v65, v109
    v_cvt_pk_bf16_f32 v230, -v67, -v111
    v_cvt_pk_bf16_f32 v215, v69, v73
    v_cvt_pk_bf16_f32 v231, -v71, -v75
    v_cvt_pk_bf16_f32 v216, v76, v80
    v_cvt_pk_bf16_f32 v232, -v78, -v82
    v_cvt_pk_bf16_f32 v217, v84, v88
    v_cvt_pk_bf16_f32 v233, -v86, -v90
    v_cvt_pk_bf16_f32 v218, v77, v81
    v_cvt_pk_bf16_f32 v234, -v79, -v83
    v_cvt_pk_bf16_f32 v219, v85, v89
    v_cvt_pk_bf16_f32 v235, -v87, -v91
    v_cvt_pk_bf16_f32 v220, v92, v92
    v_cvt_pk_bf16_f32 v236, -v94, -v94
    s_setprio 2
    v_mov_b32 v48, v18
    v_mov_b32 v49, v19
    s_cmp_eq_u32 s29, 0
    s_mov_b32 s36, s84
    s_mov_b32 s37, s85
    s_cselect_b32 s38, 1835008, 0
    s_mov_b32 s39, 0x00020000
    v_lshlrev_b32 v5, 4, v1
    s_mul_i32 s40, s2, 7168
    buffer_load_dwordx4 v[60:63], v5, s[36:39], s40 offen offset:0
    buffer_load_dwordx4 v[64:67], v5, s[36:39], s40 offen offset:1024
    buffer_load_dwordx4 v[68:71], v5, s[36:39], s40 offen offset:2048
    buffer_load_dwordx4 v[72:75], v5, s[36:39], s40 offen offset:3072
    s_add_u32 s40, s40, 4096
    buffer_load_dwordx4 v[76:79], v5, s[36:39], s40 offen offset:0
    buffer_load_dwordx4 v[80:83], v5, s[36:39], s40 offen offset:1024
    buffer_load_dwordx4 v[84:87], v5, s[36:39], s40 offen offset:2048
    s_waitcnt vmcnt(0)
sp_45:
    ds_read_b128 v[4:7], v3 offset:32
    s_waitcnt lgkmcnt(0)
    v_min_u32 v4, v4, v5
    v_min3_u32 v4, v4, v6, v7
    v_cmp_le_u32 vcc, 8, v4
    s_cbranch_vccnz sp_45_d
    s_sleep 3
    s_add_u32 s72, s72, 1
    s_cmp_lt_u32 s72, 0x80000
    s_cbranch_scc1 sp_45
sp_45_d:
    ds_write_b128 v244, v[112:115]
    ds_write_b128 v245, v[116:119]
    ds_write_b128 v246, v[120:123]
    ds_write_b128 v247, v[124:127]
    ds_write_b128 v248, v[128:131]
    ds_write_b128 v249, v[132:135]
    ds_write_b128 v250, v[136:139]
    ds_write_b128 v251, v[140:143]
    ds_read_b64_tr_b16 v[60:61], v252 offset:0
    ds_read_b64_tr_b16 v[62:63], v253 offset:0
    ds_read_b64_tr_b16 v[64:65], v252 offset:1024
    ds_read_b64_tr_b16 v[66:67], v253 offset:1024
    ds_read_b64_tr_b16 v[68:69], v252 offset:2048
    ds_read_b64_tr_b16 v[70:71], v253 offset:2048
    ds_read_b64_tr_b16 v[72:73], v252 offset:3072
    ds_read_b64_tr_b16 v[74:75], v253 offset:3072
    ds_read_b64_tr_b16 v[76:77], v48 offset:0
    ds_read_b64_tr_b16 v[78:79], v49 offset:0
    ds_read_b64_tr_b16 v[80:81], v48 offset:1024
    ds_read_b64_tr_b16 v[82:83], v49 offset:1024
    ds_read_b64_tr_b16 v[84:85], v48 offset:2048
    ds_read_b64_tr_b16 v[86:87], v49 offset:2048
    ds_read_b64_tr_b16 v[88:89], v48 offset:3072
    ds_read_b64_tr_b16 v[90:91], v49 offset:3072
    ds_write_b128 v244, v[144:147]
    ds_write_b128 v245, v[148:151]
    ds_write_b128 v246, v[152:155]
    ds_write_b128 v247, v[156:159]
    ds_write_b128 v248, v[160:163]
    ds_write_b128 v249, v[164:167]
    ds_write_b128 v250, v[168:171]
    ds_write_b128 v251, v[172:175]
    ds_read_b64_tr_b16 v[16:17], v252 offset:0
    ds_read_b64_tr_b16 v[18:19], v253 offset:0
    ds_read_b64_tr_b16 v[20:21], v252 offset:1024
    ds_read_b64_tr_b16 v[22:23], v253 offset:1024
    ds_read_b64_tr_b16 v[24:25], v252 offset:2048
    ds_read_b64_tr_b16 v[26:27], v253 offset:2048
    ds_read_b64_tr_b16 v[28:29], v252 offset:3072
    ds_read_b64_tr_b16 v[30:31], v253 offset:3072
    ds_read_b64_tr_b16 v[32:33], v48 offset:0
    ds_read_b64_tr_b16 v[34:35], v49 offset:0
    ds_read_b64_tr_b16 v[36:37], v48 offset:1024
    ds_read_b64_tr_b16 v[38:39], v49 offset:1024
    ds_read_b64_tr_b16 v[40:41], v48 offset:2048
    ds_read_b64_tr_b16 v[42:43], v49 offset:2048
    ds_read_b64_tr_b16 v[44:45], v48 offset:3072
    ds_read_b64_tr_b16 v[46:47], v49 offset:3072
    s_waitcnt lgkmcnt(14)
    v_mfma_f32_32x32x16_bf16 v[92:107], v[16:19], v[60:63], 0
    s_waitcnt lgkmcnt(12)
    v_mfma_f32_32x32x16_bf16 v[92:107], v[20:23], v[64:67], v[92:107]
    s_waitcnt lgkmcnt(10)
    v_mfma_f32_32x32x16_bf16 v[92:107], v[24:27], v[68:71], v[92:107]
    s_waitcnt lgkmcnt(8)
    v_mfma_f32_32x32x16_bf16 v[92:107], v[28:31], v[72:75], v[92:107]
    s_waitcnt lgkmcnt(6)
    v_mfma_f32_32x32x16_bf16 v[92:107], v[32:35], v[76:79], v[92:107]
    s_waitcnt lgkmcnt(4)
    v_mfma_f32_32x32x16_bf16 v[92:107], v[36:39], v[80:83], v[92:107]
    s_waitcnt lgkmcnt(2)
    v_mfma_f32_32x32x16_bf16 v[92:107], v[40:43], v[84:87], v[92:107]
    s_waitcnt lgkmcnt(0)
    v_mfma_f32_32x32x16_bf16 v[92:107], v[44:47], v[88:91], v[92:107]
    ds_write_b128 v244, v[176:179]
    ds_write_b128 v245, v[180:183]
    ds_write_b128 v246, v[184:187]
    ds_write_b128 v247, v[188:191]
    ds_write_b128 v248, v[192:195]
    ds_write_b128 v249, v[196:199]
    ds_write_b128 v250, v[200:203]
    ds_write_b128 v251, v[204:207]
    ds_read_b64_tr_b16 v[60:61], v252 offset:0
    ds_read_b64_tr_b16 v[62:63], v253 offset:0
    ds_read_b64_tr_b16 v[64:65], v252 offset:1024
    ds_read_b64_tr_b16 v[66:67], v253 offset:1024
    ds_read_b64_tr_b16 v[68:69], v252 offset:2048
    ds_read_b64_tr_b16 v[70:71], v253 offset:2048
    ds_read_b64_tr_b16 v[72:73], v252 offset:3072
    ds_read_b64_tr_b16 v[74:75], v253 offset:3072
    ds_read_b64_tr_b16 v[76:77], v48 offset:0
    ds_read_b64_tr_b16 v[78:79], v49 offset:0
    ds_read_b64_tr_b16 v[80:81], v48 offset:1024
    ds_read_b64_tr_b16 v[82:83], v49 offset:1024
    ds_read_b64_tr_b16 v[84:85], v48 offset:2048
    ds_read_b64_tr_b16 v[86:87], v49 offset:2048
    ds_read_b64_tr_b16 v[88:89], v48 offset:3072
    ds_read_b64_tr_b16 v[90:91], v49 offset:3072
    ds_write_b128 v244, v[208:211]
    ds_write_b128 v245, v[212:215]
    ds_write_b128 v246, v[216:219]
    ds_write_b128 v247, v[220:223]
    ds_write_b128 v248, v[224:227]
    ds_write_b128 v249, v[228:231]
    ds_write_b128 v250, v[232:235]
    ds_write_b128 v251, v[236:239]
    ds_read_b64_tr_b16 v[16:17], v252 offset:0
    ds_read_b64_tr_b16 v[18:19], v253 offset:0
    ds_read_b64_tr_b16 v[20:21], v252 offset:1024
    ds_read_b64_tr_b16 v[22:23], v253 offset:1024
    ds_read_b64_tr_b16 v[24:25], v252 offset:2048
    ds_read_b64_tr_b16 v[26:27], v253 offset:2048
    ds_read_b64_tr_b16 v[28:29], v252 offset:3072
    ds_read_b64_tr_b16 v[30:31], v253 offset:3072
    ds_read_b64_tr_b16 v[32:33], v48 offset:0
    ds_read_b64_tr_b16 v[34:35], v49 offset:0
    ds_read_b64_tr_b16 v[36:37], v48 offset:1024
    ds_read_b64_tr_b16 v[38:39], v49 offset:1024
    ds_read_b64_tr_b16 v[40:41], v48 offset:2048
    ds_read_b64_tr_b16 v[42:43], v49 offset:2048
    ds_read_b64_tr_b16 v[44:45], v48 offset:3072
    ds_read_b64_tr_b16 v[46:47], v49 offset:3072
    s_waitcnt lgkmcnt(14)
    v_mfma_f32_32x32x16_bf16 v[92:107], v[16:19], v[60:63], v[92:107]
    s_waitcnt lgkmcnt(12)
    v_mfma_f32_32x32x16_bf16 v[92:107], v[20:23], v[64:67], v[92:107]
    s_waitcnt lgkmcnt(10)
    v_mfma_f32_32x32x16_bf16 v[92:107], v[24:27], v[68:71], v[92:107]
    s_waitcnt lgkmcnt(8)
    v_mfma_f32_32x32x16_bf16 v[92:107], v[28:31], v[72:75], v[92:107]
    s_waitcnt lgkmcnt(6)
    v_mfma_f32_32x32x16_bf16 v[92:107], v[32:35], v[76:79], v[92:107]
    s_waitcnt lgkmcnt(4)
    v_mfma_f32_32x32x16_bf16 v[92:107], v[36:39], v[80:83], v[92:107]
    s_waitcnt lgkmcnt(2)
    v_mfma_f32_32x32x16_bf16 v[92:107], v[40:43], v[84:87], v[92:107]
    s_waitcnt lgkmcnt(0)
    v_mfma_f32_32x32x16_bf16 v[92:107], v[44:47], v[88:91], v[92:107]
    v_lshrrev_b32 v7, 5, v1
    v_lshlrev_b32 v2, 4, v1
    v_mov_b32 v112, 0
    v_mov_b32 v113, 0
    v_mov_b32 v114, 0
    v_mov_b32 v115, 0
    v_bfe_u32 v11, v1, 1, 1
    v_mul_u32_u24 v11, 4160, v11
    v_and_b32 v12, 1, v1
    v_lshl_add_u32 v11, v12, 4, v11
    v_add_u32 v11, s54, v11
    ds_write_b128 v11, v[112:115]
    s_add_u32 s61, s54, 32
    v_and_b32 v10, 31, v1
    v_lshlrev_b32 v10, 3, v10
    v_lshl_add_u32 v10, v7, 8, v10
    v_add_u32 v10, s61, v10
    s_mov_b32 s64, 0x55555555
    s_mov_b32 s65, 0x55555555
    s_mov_b32 s66, 0x11111111
    s_mov_b32 s67, 0x11111111
    v_cvt_pk_bf16_f32 v16, v100, v100
    v_cvt_pk_bf16_f32 v17, v100, v100
    v_cvt_pk_bf16_f32 v18, v101, v101
    v_cvt_pk_bf16_f32 v19, v101, v101
    v_cvt_pk_bf16_f32 v20, v102, v102
    v_cvt_pk_bf16_f32 v21, v102, v102
    v_cvt_pk_bf16_f32 v22, v103, v103
    v_cvt_pk_bf16_f32 v23, v103, v103
    v_cvt_pk_bf16_f32 v24, v104, v104
    v_cvt_pk_bf16_f32 v25, v104, v104
    v_cvt_pk_bf16_f32 v26, v98, v98
    v_cvt_pk_bf16_f32 v27, v99, v99
    v_cvt_pk_bf16_f32 v28, v96, v96
    v_cvt_pk_bf16_f32 v29, v97, v97
    v_cvt_pk_bf16_f32 v30, v92, v93
    v_cvt_pk_bf16_f32 v31, v94, v95
    s_mov_b64 exec, 1
    ds_write_b64 v10, v[24:25] offset:4088
    s_mov_b64 exec, s[64:65]
    ds_write_b64 v10, v[16:17] offset:2040
    ds_write_b64 v10, v[16:17] offset:2048
    ds_write_b64 v10, v[18:19] offset:2552
    ds_write_b64 v10, v[18:19] offset:2560
    ds_write_b64 v10, v[20:21] offset:3064
    ds_write_b64 v10, v[20:21] offset:3072
    ds_write_b64 v10, v[22:23] offset:3576
    ds_write_b64 v10, v[22:23] offset:3584
    s_mov_b64 exec, s[66:67]
    ds_write_b16 v10, v16 offset:2056
    ds_write_b16 v10, v18 offset:2568
    ds_write_b16 v10, v20 offset:3080
    ds_write_b16 v10, v22 offset:3592
    s_mov_b64 exec, -1
    ds_write_b32 v10, v26 offset:1020
    ds_write_b32 v10, v26 offset:1024
    ds_write_b32 v10, v27 offset:1532
    ds_write_b32 v10, v27 offset:1536
    s_mov_b64 exec, s[64:65]
    ds_write_b16 v10, v26 offset:1028
    ds_write_b16 v10, v27 offset:1540
    s_mov_b64 exec, -1
    ds_write_b16 v10, v28 offset:510
    ds_write_b32 v10, v28 offset:512
    ds_write_b16 v10, v29 offset:516
    ds_write_b64 v10, v[30:31]
    s_add_u32 s61, s54, 28
    v_add_u32 v4, s61, v2
    ds_read_b32 v115, v4 offset:0
    ds_read_b128 v[116:119], v4 offset:4
    ds_read_b32 v123, v4 offset:1024
    ds_read_b128 v[124:127], v4 offset:1028
    ds_read_b32 v131, v4 offset:2048
    ds_read_b128 v[132:135], v4 offset:2052
    ds_read_b32 v139, v4 offset:3072
    ds_read_b128 v[140:143], v4 offset:3076
    s_waitcnt lgkmcnt(6)
    v_alignbit_b32 v144, v116, v115, 16
    v_alignbit_b32 v145, v117, v116, 16
    v_alignbit_b32 v146, v118, v117, 16
    v_alignbit_b32 v147, v119, v118, 16
    s_waitcnt lgkmcnt(4)
    v_alignbit_b32 v148, v124, v123, 16
    v_alignbit_b32 v149, v125, v124, 16
    v_alignbit_b32 v150, v126, v125, 16
    v_alignbit_b32 v151, v127, v126, 16
    s_waitcnt lgkmcnt(2)
    v_alignbit_b32 v152, v132, v131, 16
    v_alignbit_b32 v153, v133, v132, 16
    v_alignbit_b32 v154, v134, v133, 16
    v_alignbit_b32 v155, v135, v134, 16
    s_waitcnt lgkmcnt(0)
    v_alignbit_b32 v156, v140, v139, 16
    v_alignbit_b32 v157, v141, v140, 16
    v_alignbit_b32 v158, v142, v141, 16
    v_alignbit_b32 v159, v143, v142, 16
    ds_write_b128 v4, v[144:147] offset:4164
    ds_write_b128 v4, v[148:151] offset:5188
    ds_write_b128 v4, v[152:155] offset:6212
    ds_write_b128 v4, v[156:159] offset:7236
    v_mov_b32 v5, 1
    s_lshl_b32 s61, s29, 2
    v_add_u32 v6, s61, v3
    ds_write_b32 v6, v5 offset:84
    s_branch K_conv
K_uload:
    s_setprio 3
    v_mov_b32 v3, 156864
    v_lshlrev_b32 v4, 4, v1
    s_mov_b32 s56, 0x8000
    s_mov_b32 s79, 0
K_u2:
    buffer_load_dwordx4 v[8:11], v4, s[44:47], s56 offen sc1
    s_waitcnt vmcnt(0)
    v_xor_b32 v8, v61, v8
    v_xor_b32 v9, v61, v9
    v_xor_b32 v10, v61, v10
    v_xor_b32 v11, v61, v11
    v_or3_b32 v8, v8, v9, v10
    v_or_b32 v8, v8, v11
    v_cmp_ne_u32 vcc, 0, v8
    s_cbranch_vccz K_u3
    s_sleep 8
    s_add_u32 s79, s79, 1
    s_cmp_lt_u32 s79, 0x4000
    s_cbranch_scc1 K_u2
K_u3:
    v_sub_u32 v5, 63, v1
    v_lshlrev_b32 v5, 13, v5
    s_and_b32 s56, s28, 3
    s_lshl_b32 s56, s56, 11
    s_lshr_b32 s57, s28, 2
    s_lshl_b32 s57, s57, 4
    s_add_u32 s56, s56, s57
    v_add_u32 v5, s56, v5
    s_mov_b32 m0, 139392
    s_mov_b32 s56, 1572864
    buffer_load_dwordx4 v5, s[36:39], s56 offen sc1 lds
    s_mov_b32 m0, 140416
    s_mov_b32 s56, 1048576
    buffer_load_dwordx4 v5, s[36:39], s56 offen sc1 lds
    s_mov_b32 m0, 141440
    s_mov_b32 s56, 524288
    buffer_load_dwordx4 v5, s[36:39], s56 offen sc1 lds
    s_mov_b32 m0, 142464
    s_mov_b32 s56, 0
    buffer_load_dwordx4 v5, s[36:39], s56 offen sc1 lds
    s_mov_b32 m0, 152288
    s_mov_b32 s56, 1573888
    buffer_load_dwordx4 v5, s[36:39], s56 offen sc1 lds
    s_mov_b32 m0, 153312
    s_mov_b32 s56, 1049600
    buffer_load_dwordx4 v5, s[36:39], s56 offen sc1 lds
    s_mov_b32 m0, 154336
    s_mov_b32 s56, 525312
    buffer_load_dwordx4 v5, s[36:39], s56 offen sc1 lds
    s_mov_b32 m0, 155360
    s_mov_b32 s56, 1024
    buffer_load_dwordx4 v5, s[36:39], s56 offen sc1 lds
    v_mov_b32 v8, 0
    v_mov_b32 v9, 0
    v_mov_b32 v10, 0
    v_mov_b32 v11, 0
    v_min_u32 v7, 29, v1
    v_lshlrev_b32 v7, 4, v7
    v_add_u32 v7, 143488, v7
    ds_write_b128 v7, v[8:11]
    ds_write_b128 v7, v[8:11] offset:12896
    s_nop 0
    v_mov_b32 v8, 1
    v_mov_b32 v9, 1
    s_waitcnt vmcnt(0) lgkmcnt(0)
    ds_write2_b32 v3, v8, v9 offset0:23 offset1:24
K_conv:
    s_sub_u32 s48, s3, 4
    s_lshr_b32 s49, s48, 1
    s_and_b32 s50, s48, 1
    s_lshl_b32 s51, s28, 1
    s_add_u32 s51, s51, s49
    s_lshl_b32 s52, s28, 2
    s_load_dword s53, s[92:93], s52
    s_mul_i32 s54, s49, 12896
    s_add_u32 s54, s54, 131072
    v_and_b32 v2, 15, v1
    v_lshrrev_b32 v3, 4, v1
    v_lshlrev_b32 v4, 4, v1
    v_mov_b32 v17, 1
    s_lshl_b32 s56, s48, 2
    s_add_u32 s56, s56, 156864
    v_mov_b32 v18, s56
    v_xor_b32 v19, 4, v18
    s_lshl_b32 s56, s49, 2
    s_add_u32 s56, s56, 156864
    v_mov_b32 v22, s56
    v_lshrrev_b32 v6, 1, v2
    v_lshlrev_b32 v6, 2, v6
    v_lshl_add_u32 v6, v3, 4, v6
    v_and_b32 v7, 1, v2
    v_sub_u32 v7, 1, v7
    v_mul_u32_u24 v7, 4160, v7
    v_add_u32 v6, v6, v7
    s_lshl_b32 s56, s50, 8
    s_add_u32 s56, s56, s54
    s_add_u32 s57, s56, 4
    v_add_u32 v12, s57, v6
    v_add_u32 v13, 1024, v12
    v_add_u32 v14, 2048, v12
    v_add_u32 v15, 3072, v12
    v_lshlrev_b32 v6, 4, v3
    v_lshlrev_b32 v7, 5, v2
    v_sub_u32 v6, v6, v7
    s_add_u32 s57, s56, 8800
    v_add_u32 v16, s57, v6
    v_lshlrev_b32 v8, 5, v2
    v_lshl_add_u32 v8, v3, 3, v8
    s_lshl_b32 s56, s50, 11
    s_add_u32 s57, s54, 10872
    s_sub_u32 s57, s57, s56
    v_sub_u32 v8, s57, v8
    s_lshl_b32 s56, s48, 15
    s_add_u32 s56, s56, 28672
    v_add_u32 v6, s56, v4
    v_xor_b32 v7, 0x8000, v6
    s_add_u32 s40, s24, 16777216
    s_addc_u32 s41, s25, 0
    s_mov_b32 s42, 2097152
    s_mov_b32 s43, 0x00020000
    s_add_u32 s44, s24, 20971520
    s_addc_u32 s45, s25, 0
    s_mov_b32 s46, 786432
    s_mov_b32 s47, 0x00020000
sp_46:
    ds_read2_b32 v[20:21], v22 offset0:21 offset1:23
    s_waitcnt lgkmcnt(0)
    v_min_u32 v20, v20, v21
    v_cmp_eq_u32 vcc, 1, v20
    s_cbranch_vccnz sp_46_d
    s_sleep 1
    s_add_u32 s72, s72, 1
    s_cmp_lt_u32 s72, 0x80000
    s_cbranch_scc1 sp_46
sp_46_d:
    v_mov_b32 v23, 156864
    ds_read_b32 v61, v23 offset:80
    s_lshl_b32 s56, s49, 4
    s_lshr_b32 s53, s53, s56
    s_lshl_b32 s53, s53, 16
    ds_read_b64 v[192:193], v8 offset:1536
    ds_read_b64 v[194:195], v8 offset:1024
    ds_read_b64 v[196:197], v8 offset:512
    ds_read_b64 v[198:199], v8 offset:0
    ds_read2_b32 v[64:65], v12 offset0:0 offset1:1
    ds_read2_b32 v[66:67], v12 offset0:2 offset1:3
    ds_read_b128 v[96:99], v16 offset:3584
    ds_read2_b32 v[68:69], v12 offset0:128 offset1:129
    ds_read2_b32 v[70:71], v12 offset0:130 offset1:131
    ds_read_b128 v[100:103], v16 offset:3072
    ds_read2_b32 v[72:73], v13 offset0:0 offset1:1
    ds_read2_b32 v[74:75], v13 offset0:2 offset1:3
    ds_read_b128 v[104:107], v16 offset:2560
    ds_read2_b32 v[76:77], v13 offset0:128 offset1:129
    ds_read2_b32 v[78:79], v13 offset0:130 offset1:131
    ds_read_b128 v[108:111], v16 offset:2048
    ds_read2_b32 v[80:81], v14 offset0:0 offset1:1
    ds_read2_b32 v[82:83], v14 offset0:2 offset1:3
    ds_read_b128 v[112:115], v16 offset:1536
    ds_read2_b32 v[84:85], v14 offset0:128 offset1:129
    ds_read2_b32 v[86:87], v14 offset0:130 offset1:131
    ds_read_b128 v[116:119], v16 offset:1024
    ds_read2_b32 v[88:89], v15 offset0:0 offset1:1
    ds_read2_b32 v[90:91], v15 offset0:2 offset1:3
    ds_read_b128 v[120:123], v16 offset:512
    ds_read2_b32 v[92:93], v15 offset0:128 offset1:129
    ds_read2_b32 v[94:95], v15 offset0:130 offset1:131
    ds_read_b128 v[124:127], v16 offset:0
    s_waitcnt lgkmcnt(15)
    v_and_b32 v200, 0xffff0000, v193
    v_lshlrev_b32 v201, 16, v193
    v_and_b32 v202, 0xffff0000, v192
    v_lshlrev_b32 v203, 16, v192
    v_and_b32 v204, 0xffff0000, v195
    v_lshlrev_b32 v205, 16, v195
    v_and_b32 v206, 0xffff0000, v194
    v_lshlrev_b32 v207, 16, v194
    v_and_b32 v208, 0xffff0000, v197
    v_lshlrev_b32 v209, 16, v197
    v_and_b32 v210, 0xffff0000, v196
    v_lshlrev_b32 v211, 16, v196
    v_and_b32 v212, 0xffff0000, v199
    v_lshlrev_b32 v213, 16, v199
    v_and_b32 v214, 0xffff0000, v198
    v_lshlrev_b32 v215, 16, v198
    v_mul_f32 v200, s53, v200
    v_mul_f32 v201, s53, v201
    v_mul_f32 v202, s53, v202
    v_mul_f32 v203, s53, v203
    v_mul_f32 v204, s53, v204
    v_mul_f32 v205, s53, v205
    v_mul_f32 v206, s53, v206
    v_mul_f32 v207, s53, v207
    v_mul_f32 v208, s53, v208
    v_mul_f32 v209, s53, v209
    v_mul_f32 v210, s53, v210
    v_mul_f32 v211, s53, v211
    v_mul_f32 v212, s53, v212
    v_mul_f32 v213, s53, v213
    v_mul_f32 v214, s53, v214
    v_mul_f32 v215, s53, v215
    v_cvt_pk_bf16_f32 v216, v200, v201
    v_cvt_pk_bf16_f32 v217, v202, v203
    v_cvt_pk_bf16_f32 v218, v204, v205
    v_cvt_pk_bf16_f32 v219, v206, v207
    v_cvt_pk_bf16_f32 v220, v208, v209
    v_cvt_pk_bf16_f32 v221, v210, v211
    v_cvt_pk_bf16_f32 v222, v212, v213
    v_cvt_pk_bf16_f32 v223, v214, v215
    v_lshlrev_b32 v200, 16, v216
    v_and_b32 v201, 0xffff0000, v216
    v_lshlrev_b32 v202, 16, v217
    v_and_b32 v203, 0xffff0000, v217
    v_lshlrev_b32 v204, 16, v218
    v_and_b32 v205, 0xffff0000, v218
    v_lshlrev_b32 v206, 16, v219
    v_and_b32 v207, 0xffff0000, v219
    v_lshlrev_b32 v208, 16, v220
    v_and_b32 v209, 0xffff0000, v220
    v_lshlrev_b32 v210, 16, v221
    v_and_b32 v211, 0xffff0000, v221
    v_lshlrev_b32 v212, 16, v222
    v_and_b32 v213, 0xffff0000, v222
    v_lshlrev_b32 v214, 16, v223
    v_and_b32 v215, 0xffff0000, v223
    s_setprio 0
    s_waitcnt lgkmcnt(0)
    v_mfma_f32_16x16x32_bf16 v[24:27], v[64:67], v[96:99], 0
    ds_read2_b32 v[128:129], v12 offset0:16 offset1:17
    v_mfma_f32_16x16x32_bf16 v[28:31], v[64:67], v[100:103], 0
    ds_read2_b32 v[130:131], v12 offset0:18 offset1:19
    v_mfma_f32_16x16x32_bf16 v[32:35], v[64:67], v[104:107], 0
    ds_read_b128 v[160:163], v16 offset:3648
    v_mfma_f32_16x16x32_bf16 v[36:39], v[64:67], v[108:111], 0
    ds_read2_b32 v[132:133], v12 offset0:144 offset1:145
    v_mfma_f32_16x16x32_bf16 v[40:43], v[64:67], v[112:115], 0
    ds_read2_b32 v[134:135], v12 offset0:146 offset1:147
    v_mfma_f32_16x16x32_bf16 v[44:47], v[64:67], v[116:119], 0
    ds_read_b128 v[164:167], v16 offset:3136
    v_mfma_f32_16x16x32_bf16 v[48:51], v[64:67], v[120:123], 0
    ds_read2_b32 v[136:137], v13 offset0:16 offset1:17
    v_mfma_f32_16x16x32_bf16 v[52:55], v[64:67], v[124:127], 0
    ds_read2_b32 v[138:139], v13 offset0:18 offset1:19
    v_mfma_f32_16x16x32_bf16 v[28:31], v[68:71], v[96:99], v[28:31]
    ds_read_b128 v[168:171], v16 offset:2624
    v_mfma_f32_16x16x32_bf16 v[32:35], v[68:71], v[100:103], v[32:35]
    ds_read2_b32 v[140:141], v13 offset0:144 offset1:145
    v_mfma_f32_16x16x32_bf16 v[36:39], v[68:71], v[104:107], v[36:39]
    ds_read2_b32 v[142:143], v13 offset0:146 offset1:147
    v_mfma_f32_16x16x32_bf16 v[40:43], v[68:71], v[108:111], v[40:43]
    ds_read_b128 v[172:175], v16 offset:2112
    v_mfma_f32_16x16x32_bf16 v[44:47], v[68:71], v[112:115], v[44:47]
    ds_read2_b32 v[144:145], v14 offset0:16 offset1:17
    v_mfma_f32_16x16x32_bf16 v[48:51], v[68:71], v[116:119], v[48:51]
    ds_read2_b32 v[146:147], v14 offset0:18 offset1:19
    v_mfma_f32_16x16x32_bf16 v[52:55], v[68:71], v[120:123], v[52:55]
    ds_read_b128 v[176:179], v16 offset:1600
    v_mfma_f32_16x16x32_bf16 v[32:35], v[72:75], v[96:99], v[32:35]
    ds_read2_b32 v[148:149], v14 offset0:144 offset1:145
    v_mfma_f32_16x16x32_bf16 v[36:39], v[72:75], v[100:103], v[36:39]
    ds_read2_b32 v[150:151], v14 offset0:146 offset1:147
    v_mfma_f32_16x16x32_bf16 v[40:43], v[72:75], v[104:107], v[40:43]
    ds_read_b128 v[180:183], v16 offset:1088
    v_mfma_f32_16x16x32_bf16 v[44:47], v[72:75], v[108:111], v[44:47]
    ds_read2_b32 v[152:153], v15 offset0:16 offset1:17
    v_mfma_f32_16x16x32_bf16 v[48:51], v[72:75], v[112:115], v[48:51]
    ds_read2_b32 v[154:155], v15 offset0:18 offset1:19
    v_mfma_f32_16x16x32_bf16 v[52:55], v[72:75], v[116:119], v[52:55]
    ds_read_b128 v[184:187], v16 offset:576
    v_mfma_f32_16x16x32_bf16 v[36:39], v[76:79], v[96:99], v[36:39]
    ds_read2_b32 v[156:157], v15 offset0:144 offset1:145
    v_mfma_f32_16x16x32_bf16 v[40:43], v[76:79], v[100:103], v[40:43]
    ds_read2_b32 v[158:159], v15 offset0:146 offset1:147
    v_mfma_f32_16x16x32_bf16 v[44:47], v[76:79], v[104:107], v[44:47]
    ds_read_b128 v[188:191], v16 offset:64
    v_mfma_f32_16x16x32_bf16 v[48:51], v[76:79], v[108:111], v[48:51]
    v_mfma_f32_16x16x32_bf16 v[52:55], v[76:79], v[112:115], v[52:55]
    v_mfma_f32_16x16x32_bf16 v[40:43], v[80:83], v[96:99], v[40:43]
    v_mfma_f32_16x16x32_bf16 v[44:47], v[80:83], v[100:103], v[44:47]
    v_mfma_f32_16x16x32_bf16 v[48:51], v[80:83], v[104:107], v[48:51]
    v_mfma_f32_16x16x32_bf16 v[52:55], v[80:83], v[108:111], v[52:55]
    v_mfma_f32_16x16x32_bf16 v[44:47], v[84:87], v[96:99], v[44:47]
    v_mfma_f32_16x16x32_bf16 v[48:51], v[84:87], v[100:103], v[48:51]
    v_mfma_f32_16x16x32_bf16 v[52:55], v[84:87], v[104:107], v[52:55]
    v_mfma_f32_16x16x32_bf16 v[48:51], v[88:91], v[96:99], v[48:51]
    v_mfma_f32_16x16x32_bf16 v[52:55], v[88:91], v[100:103], v[52:55]
    v_mfma_f32_16x16x32_bf16 v[52:55], v[92:95], v[96:99], v[52:55]
    s_waitcnt lgkmcnt(0)
    v_mfma_f32_16x16x32_bf16 v[24:27], v[128:131], v[160:163], v[24:27]
    ds_read2_b32 v[64:65], v12 offset0:32 offset1:33
    v_mfma_f32_16x16x32_bf16 v[28:31], v[128:131], v[164:167], v[28:31]
    ds_read2_b32 v[66:67], v12 offset0:34 offset1:35
    v_mfma_f32_16x16x32_bf16 v[32:35], v[128:131], v[168:171], v[32:35]
    ds_read_b128 v[96:99], v16 offset:3712
    v_mfma_f32_16x16x32_bf16 v[36:39], v[128:131], v[172:175], v[36:39]
    ds_read2_b32 v[68:69], v12 offset0:160 offset1:161
    v_mfma_f32_16x16x32_bf16 v[40:43], v[128:131], v[176:179], v[40:43]
    ds_read2_b32 v[70:71], v12 offset0:162 offset1:163
    v_mfma_f32_16x16x32_bf16 v[44:47], v[128:131], v[180:183], v[44:47]
    ds_read_b128 v[100:103], v16 offset:3200
    v_mfma_f32_16x16x32_bf16 v[48:51], v[128:131], v[184:187], v[48:51]
    ds_read2_b32 v[72:73], v13 offset0:32 offset1:33
    v_mfma_f32_16x16x32_bf16 v[52:55], v[128:131], v[188:191], v[52:55]
    ds_read2_b32 v[74:75], v13 offset0:34 offset1:35
    v_mfma_f32_16x16x32_bf16 v[28:31], v[132:135], v[160:163], v[28:31]
    ds_read_b128 v[104:107], v16 offset:2688
    v_mfma_f32_16x16x32_bf16 v[32:35], v[132:135], v[164:167], v[32:35]
    ds_read2_b32 v[76:77], v13 offset0:160 offset1:161
    v_mfma_f32_16x16x32_bf16 v[36:39], v[132:135], v[168:171], v[36:39]
    ds_read2_b32 v[78:79], v13 offset0:162 offset1:163
    v_mfma_f32_16x16x32_bf16 v[40:43], v[132:135], v[172:175], v[40:43]
    ds_read_b128 v[108:111], v16 offset:2176
    v_mfma_f32_16x16x32_bf16 v[44:47], v[132:135], v[176:179], v[44:47]
    ds_read2_b32 v[80:81], v14 offset0:32 offset1:33
    v_mfma_f32_16x16x32_bf16 v[48:51], v[132:135], v[180:183], v[48:51]
    ds_read2_b32 v[82:83], v14 offset0:34 offset1:35
    v_mfma_f32_16x16x32_bf16 v[52:55], v[132:135], v[184:187], v[52:55]
    ds_read_b128 v[112:115], v16 offset:1664
    v_mfma_f32_16x16x32_bf16 v[32:35], v[136:139], v[160:163], v[32:35]
    ds_read2_b32 v[84:85], v14 offset0:160 offset1:161
    v_mfma_f32_16x16x32_bf16 v[36:39], v[136:139], v[164:167], v[36:39]
    ds_read2_b32 v[86:87], v14 offset0:162 offset1:163
    v_mfma_f32_16x16x32_bf16 v[40:43], v[136:139], v[168:171], v[40:43]
    ds_read_b128 v[116:119], v16 offset:1152
    v_mfma_f32_16x16x32_bf16 v[44:47], v[136:139], v[172:175], v[44:47]
    ds_read2_b32 v[88:89], v15 offset0:32 offset1:33
    v_mfma_f32_16x16x32_bf16 v[48:51], v[136:139], v[176:179], v[48:51]
    ds_read2_b32 v[90:91], v15 offset0:34 offset1:35
    v_mfma_f32_16x16x32_bf16 v[52:55], v[136:139], v[180:183], v[52:55]
    ds_read_b128 v[120:123], v16 offset:640
    v_mfma_f32_16x16x32_bf16 v[36:39], v[140:143], v[160:163], v[36:39]
    ds_read2_b32 v[92:93], v15 offset0:160 offset1:161
    v_mfma_f32_16x16x32_bf16 v[40:43], v[140:143], v[164:167], v[40:43]
    ds_read2_b32 v[94:95], v15 offset0:162 offset1:163
    v_mfma_f32_16x16x32_bf16 v[44:47], v[140:143], v[168:171], v[44:47]
    ds_read_b128 v[124:127], v16 offset:128
    v_mfma_f32_16x16x32_bf16 v[48:51], v[140:143], v[172:175], v[48:51]
    v_mfma_f32_16x16x32_bf16 v[52:55], v[140:143], v[176:179], v[52:55]
    v_mfma_f32_16x16x32_bf16 v[40:43], v[144:147], v[160:163], v[40:43]
    v_mfma_f32_16x16x32_bf16 v[44:47], v[144:147], v[164:167], v[44:47]
    v_mfma_f32_16x16x32_bf16 v[48:51], v[144:147], v[168:171], v[48:51]
    v_mfma_f32_16x16x32_bf16 v[52:55], v[144:147], v[172:175], v[52:55]
    v_mfma_f32_16x16x32_bf16 v[44:47], v[148:151], v[160:163], v[44:47]
    v_mfma_f32_16x16x32_bf16 v[48:51], v[148:151], v[164:167], v[48:51]
    v_mfma_f32_16x16x32_bf16 v[52:55], v[148:151], v[168:171], v[52:55]
    v_mfma_f32_16x16x32_bf16 v[48:51], v[152:155], v[160:163], v[48:51]
    v_mfma_f32_16x16x32_bf16 v[52:55], v[152:155], v[164:167], v[52:55]
    v_mfma_f32_16x16x32_bf16 v[52:55], v[156:159], v[160:163], v[52:55]
    s_waitcnt lgkmcnt(0)
    v_mfma_f32_16x16x32_bf16 v[24:27], v[64:67], v[96:99], v[24:27]
    ds_read2_b32 v[128:129], v12 offset0:48 offset1:49
    v_mfma_f32_16x16x32_bf16 v[28:31], v[64:67], v[100:103], v[28:31]
    ds_read2_b32 v[130:131], v12 offset0:50 offset1:51
    v_mfma_f32_16x16x32_bf16 v[32:35], v[64:67], v[104:107], v[32:35]
    ds_read_b128 v[160:163], v16 offset:3776
    v_mfma_f32_16x16x32_bf16 v[36:39], v[64:67], v[108:111], v[36:39]
    ds_read2_b32 v[132:133], v12 offset0:176 offset1:177
    v_mfma_f32_16x16x32_bf16 v[40:43], v[64:67], v[112:115], v[40:43]
    ds_read2_b32 v[134:135], v12 offset0:178 offset1:179
    v_mfma_f32_16x16x32_bf16 v[44:47], v[64:67], v[116:119], v[44:47]
    ds_read_b128 v[164:167], v16 offset:3264
    v_mfma_f32_16x16x32_bf16 v[48:51], v[64:67], v[120:123], v[48:51]
    ds_read2_b32 v[136:137], v13 offset0:48 offset1:49
    v_mfma_f32_16x16x32_bf16 v[52:55], v[64:67], v[124:127], v[52:55]
    ds_read2_b32 v[138:139], v13 offset0:50 offset1:51
    v_mfma_f32_16x16x32_bf16 v[28:31], v[68:71], v[96:99], v[28:31]
    ds_read_b128 v[168:171], v16 offset:2752
    v_mfma_f32_16x16x32_bf16 v[32:35], v[68:71], v[100:103], v[32:35]
    ds_read2_b32 v[140:141], v13 offset0:176 offset1:177
    v_mfma_f32_16x16x32_bf16 v[36:39], v[68:71], v[104:107], v[36:39]
    ds_read2_b32 v[142:143], v13 offset0:178 offset1:179
    v_mfma_f32_16x16x32_bf16 v[40:43], v[68:71], v[108:111], v[40:43]
    ds_read_b128 v[172:175], v16 offset:2240
    v_mfma_f32_16x16x32_bf16 v[44:47], v[68:71], v[112:115], v[44:47]
    ds_read2_b32 v[144:145], v14 offset0:48 offset1:49
    v_mfma_f32_16x16x32_bf16 v[48:51], v[68:71], v[116:119], v[48:51]
    ds_read2_b32 v[146:147], v14 offset0:50 offset1:51
    v_mfma_f32_16x16x32_bf16 v[52:55], v[68:71], v[120:123], v[52:55]
    ds_read_b128 v[176:179], v16 offset:1728
    v_mfma_f32_16x16x32_bf16 v[32:35], v[72:75], v[96:99], v[32:35]
    ds_read2_b32 v[148:149], v14 offset0:176 offset1:177
    v_mfma_f32_16x16x32_bf16 v[36:39], v[72:75], v[100:103], v[36:39]
    ds_read2_b32 v[150:151], v14 offset0:178 offset1:179
    v_mfma_f32_16x16x32_bf16 v[40:43], v[72:75], v[104:107], v[40:43]
    ds_read_b128 v[180:183], v16 offset:1216
    v_mfma_f32_16x16x32_bf16 v[44:47], v[72:75], v[108:111], v[44:47]
    ds_read2_b32 v[152:153], v15 offset0:48 offset1:49
    v_mfma_f32_16x16x32_bf16 v[48:51], v[72:75], v[112:115], v[48:51]
    ds_read2_b32 v[154:155], v15 offset0:50 offset1:51
    v_mfma_f32_16x16x32_bf16 v[52:55], v[72:75], v[116:119], v[52:55]
    ds_read_b128 v[184:187], v16 offset:704
    v_mfma_f32_16x16x32_bf16 v[36:39], v[76:79], v[96:99], v[36:39]
    ds_read2_b32 v[156:157], v15 offset0:176 offset1:177
    v_mfma_f32_16x16x32_bf16 v[40:43], v[76:79], v[100:103], v[40:43]
    ds_read2_b32 v[158:159], v15 offset0:178 offset1:179
    v_mfma_f32_16x16x32_bf16 v[44:47], v[76:79], v[104:107], v[44:47]
    ds_read_b128 v[188:191], v16 offset:192
    v_mfma_f32_16x16x32_bf16 v[48:51], v[76:79], v[108:111], v[48:51]
    v_mfma_f32_16x16x32_bf16 v[52:55], v[76:79], v[112:115], v[52:55]
    v_mfma_f32_16x16x32_bf16 v[40:43], v[80:83], v[96:99], v[40:43]
    v_mfma_f32_16x16x32_bf16 v[44:47], v[80:83], v[100:103], v[44:47]
    v_mfma_f32_16x16x32_bf16 v[48:51], v[80:83], v[104:107], v[48:51]
    v_mfma_f32_16x16x32_bf16 v[52:55], v[80:83], v[108:111], v[52:55]
    v_mfma_f32_16x16x32_bf16 v[44:47], v[84:87], v[96:99], v[44:47]
    v_mfma_f32_16x16x32_bf16 v[48:51], v[84:87], v[100:103], v[48:51]
    v_mfma_f32_16x16x32_bf16 v[52:55], v[84:87], v[104:107], v[52:55]
    v_mfma_f32_16x16x32_bf16 v[48:51], v[88:91], v[96:99], v[48:51]
    v_mfma_f32_16x16x32_bf16 v[52:55], v[88:91], v[100:103], v[52:55]
    v_mfma_f32_16x16x32_bf16 v[52:55], v[92:95], v[96:99], v[52:55]
    s_waitcnt lgkmcnt(0)
    v_mfma_f32_16x16x32_bf16 v[24:27], v[128:131], v[160:163], v[24:27]
    v_mfma_f32_16x16x32_bf16 v[28:31], v[128:131], v[164:167], v[28:31]
    v_mfma_f32_16x16x32_bf16 v[32:35], v[128:131], v[168:171], v[32:35]
    v_mfma_f32_16x16x32_bf16 v[36:39], v[128:131], v[172:175], v[36:39]
    v_mfma_f32_16x16x32_bf16 v[40:43], v[128:131], v[176:179], v[40:43]
    v_mfma_f32_16x16x32_bf16 v[44:47], v[128:131], v[180:183], v[44:47]
    v_mfma_f32_16x16x32_bf16 v[48:51], v[128:131], v[184:187], v[48:51]
    v_mfma_f32_16x16x32_bf16 v[52:55], v[128:131], v[188:191], v[52:55]
    v_mfma_f32_16x16x32_bf16 v[28:31], v[132:135], v[160:163], v[28:31]
    v_mfma_f32_16x16x32_bf16 v[32:35], v[132:135], v[164:167], v[32:35]
    v_mfma_f32_16x16x32_bf16 v[36:39], v[132:135], v[168:171], v[36:39]
    v_mfma_f32_16x16x32_bf16 v[40:43], v[132:135], v[172:175], v[40:43]
    v_mfma_f32_16x16x32_bf16 v[44:47], v[132:135], v[176:179], v[44:47]
    v_mfma_f32_16x16x32_bf16 v[48:51], v[132:135], v[180:183], v[48:51]
    v_mfma_f32_16x16x32_bf16 v[52:55], v[132:135], v[184:187], v[52:55]
    v_mfma_f32_16x16x32_bf16 v[32:35], v[136:139], v[160:163], v[32:35]
    v_mfma_f32_16x16x32_bf16 v[36:39], v[136:139], v[164:167], v[36:39]
    v_mfma_f32_16x16x32_bf16 v[40:43], v[136:139], v[168:171], v[40:43]
    v_mfma_f32_16x16x32_bf16 v[44:47], v[136:139], v[172:175], v[44:47]
    v_mfma_f32_16x16x32_bf16 v[48:51], v[136:139], v[176:179], v[48:51]
    v_mfma_f32_16x16x32_bf16 v[52:55], v[136:139], v[180:183], v[52:55]
    v_mfma_f32_16x16x32_bf16 v[36:39], v[140:143], v[160:163], v[36:39]
    v_mfma_f32_16x16x32_bf16 v[40:43], v[140:143], v[164:167], v[40:43]
    v_mfma_f32_16x16x32_bf16 v[44:47], v[140:143], v[168:171], v[44:47]
    v_mfma_f32_16x16x32_bf16 v[48:51], v[140:143], v[172:175], v[48:51]
    v_mfma_f32_16x16x32_bf16 v[52:55], v[140:143], v[176:179], v[52:55]
    v_mfma_f32_16x16x32_bf16 v[40:43], v[144:147], v[160:163], v[40:43]
    v_mfma_f32_16x16x32_bf16 v[44:47], v[144:147], v[164:167], v[44:47]
    v_mfma_f32_16x16x32_bf16 v[48:51], v[144:147], v[168:171], v[48:51]
    v_mfma_f32_16x16x32_bf16 v[52:55], v[144:147], v[172:175], v[52:55]
    v_mfma_f32_16x16x32_bf16 v[44:47], v[148:151], v[160:163], v[44:47]
    v_mfma_f32_16x16x32_bf16 v[48:51], v[148:151], v[164:167], v[48:51]
    v_mfma_f32_16x16x32_bf16 v[52:55], v[148:151], v[168:171], v[52:55]
    v_mfma_f32_16x16x32_bf16 v[48:51], v[152:155], v[160:163], v[48:51]
    v_mfma_f32_16x16x32_bf16 v[52:55], v[152:155], v[164:167], v[52:55]
    v_mfma_f32_16x16x32_bf16 v[52:55], v[156:159], v[160:163], v[52:55]
    s_setprio 3
    s_cmp_eq_u32 s50, 0
    s_cbranch_scc1 K_x0
    ds_write_b128 v6, v[24:27] offset:0
    ds_write_b128 v6, v[28:31] offset:1024
    ds_write_b128 v6, v[32:35] offset:2048
    ds_write_b128 v6, v[36:39] offset:3072
    ds_write_b32 v18, v17 offset:112
    v_mov_b32 v64, v40
    v_mov_b32 v65, v41
    v_mov_b32 v66, v42
    v_mov_b32 v67, v43
    v_mov_b32 v68, v44
    v_mov_b32 v69, v45
    v_mov_b32 v70, v46
    v_mov_b32 v71, v47
    v_mov_b32 v72, v48
    v_mov_b32 v73, v49
    v_mov_b32 v74, v50
    v_mov_b32 v75, v51
    v_mov_b32 v76, v52
    v_mov_b32 v77, v53
    v_mov_b32 v78, v54
    v_mov_b32 v79, v55
    s_branch K_xe
K_x0:
    ds_write_b128 v6, v[40:43] offset:0
    ds_write_b128 v6, v[44:47] offset:1024
    s_nop 0
    ds_write_b128 v6, v[48:51] offset:2048
    s_nop 0
    ds_write_b128 v6, v[52:55] offset:3072
    ds_write_b32 v18, v17 offset:112
    v_mov_b32 v64, v24
    v_mov_b32 v65, v25
    v_mov_b32 v66, v26
    v_mov_b32 v67, v27
    v_mov_b32 v68, v28
    v_mov_b32 v69, v29
    v_mov_b32 v70, v30
    v_mov_b32 v71, v31
    v_mov_b32 v72, v32
    v_mov_b32 v73, v33
    v_mov_b32 v74, v34
    v_mov_b32 v75, v35
    v_mov_b32 v76, v36
    v_mov_b32 v77, v37
    v_mov_b32 v78, v38
    v_mov_b32 v79, v39
K_xe:
    v_and_b32 v8, 1, v3
    v_lshlrev_b32 v8, 9, v8
    v_lshl_add_u32 v8, v2, 5, v8
    v_lshrrev_b32 v9, 1, v3
    v_lshl_add_u32 v8, v9, 4, v8
    s_lshl_b32 s56, s51, 12
    s_lshl_b32 s57, s50, 11
    s_add_u32 s56, s56, s57
sp_47:
    ds_read_b32 v20, v19 offset:112
    s_waitcnt lgkmcnt(0)
    v_cmp_eq_u32 vcc, 1, v20
    s_cbranch_vccnz sp_47_d
    s_add_u32 s72, s72, 1
    s_cmp_lt_u32 s72, 0x80000
    s_cbranch_scc1 sp_47
sp_47_d:
    ds_read_b128 v[80:83], v7 offset:0
    ds_read_b128 v[84:87], v7 offset:1024
    ds_read_b128 v[88:91], v7 offset:2048
    ds_read_b128 v[92:95], v7 offset:3072
    s_waitcnt lgkmcnt(0)
    v_add_f32 v64, v64, v80
    v_add_f32 v65, v65, v81
    v_add_f32 v66, v66, v82
    v_add_f32 v67, v67, v83
    v_add_f32 v68, v68, v84
    v_add_f32 v69, v69, v85
    v_add_f32 v70, v70, v86
    v_add_f32 v71, v71, v87
    v_add_f32 v72, v72, v88
    v_add_f32 v73, v73, v89
    v_add_f32 v74, v74, v90
    v_add_f32 v75, v75, v91
    v_add_f32 v76, v76, v92
    v_add_f32 v77, v77, v93
    v_add_f32 v78, v78, v94
    v_add_f32 v79, v79, v95
    v_cvt_pk_bf16_f32 v216, v64, v65
    v_cvt_pk_bf16_f32 v217, v66, v67
    v_cvt_pk_bf16_f32 v218, v68, v69
    v_cvt_pk_bf16_f32 v219, v70, v71
    v_cvt_pk_bf16_f32 v220, v72, v73
    v_cvt_pk_bf16_f32 v221, v74, v75
    v_cvt_pk_bf16_f32 v222, v76, v77
    v_cvt_pk_bf16_f32 v223, v78, v79
    v_lshlrev_b32 v64, 16, v216
    v_and_b32 v65, 0xffff0000, v216
    v_lshlrev_b32 v66, 16, v217
    v_and_b32 v67, 0xffff0000, v217
    v_lshlrev_b32 v68, 16, v218
    v_and_b32 v69, 0xffff0000, v218
    v_lshlrev_b32 v70, 16, v219
    v_and_b32 v71, 0xffff0000, v219
    v_lshlrev_b32 v72, 16, v220
    v_and_b32 v73, 0xffff0000, v220
    v_lshlrev_b32 v74, 16, v221
    v_and_b32 v75, 0xffff0000, v221
    v_lshlrev_b32 v76, 16, v222
    v_and_b32 v77, 0xffff0000, v222
    v_lshlrev_b32 v78, 16, v223
    v_and_b32 v79, 0xffff0000, v223
    v_add_f32 v64, v64, v200
    v_add_f32 v65, v65, v201
    v_add_f32 v66, v66, v202
    v_add_f32 v67, v67, v203
    v_add_f32 v68, v68, v204
    v_add_f32 v69, v69, v205
    v_add_f32 v70, v70, v206
    v_add_f32 v71, v71, v207
    v_add_f32 v72, v72, v208
    v_add_f32 v73, v73, v209
    v_add_f32 v74, v74, v210
    v_add_f32 v75, v75, v211
    v_add_f32 v76, v76, v212
    v_add_f32 v77, v77, v213
    v_add_f32 v78, v78, v214
    v_add_f32 v79, v79, v215
    v_cvt_pk_bf16_f32 v216, v64, v65
    v_cvt_pk_bf16_f32 v217, v66, v67
    v_cvt_pk_bf16_f32 v218, v68, v69
    v_cvt_pk_bf16_f32 v219, v70, v71
    v_cvt_pk_bf16_f32 v220, v72, v73
    v_cvt_pk_bf16_f32 v221, v74, v75
    v_cvt_pk_bf16_f32 v222, v76, v77
    v_cvt_pk_bf16_f32 v223, v78, v79
    v_permlane16_swap_b32 v216, v218
    v_permlane16_swap_b32 v217, v219
    v_permlane16_swap_b32 v220, v222
    v_permlane16_swap_b32 v221, v223
    buffer_store_dwordx4 v[216:219], v8, s[40:43], s56 offen offset:0 sc1
    buffer_store_dwordx4 v[220:223], v8, s[40:43], s56 offen offset:1024 sc1
    v_lshrrev_b32 v8, 3, v1
    v_and_b32 v9, 7, v1
    v_lshlrev_b32 v10, 12, v8
    v_lshl_add_u32 v10, v9, 4, v10
    v_bfe_u32 v11, v8, 1, 2
    v_lshlrev_b32 v11, 1, v11
    v_xor_b32 v11, v11, v9
    v_lshlrev_b32 v11, 4, v11
    v_lshl_add_u32 v11, v8, 7, v11
    s_lshl_b32 s57, s50, 11
    s_add_u32 s57, s57, s54
    v_add_u32 v11, s57, v11
    s_lshl_b32 s56, s81, 6
    s_lshl_b32 s57, s48, 4
    s_add_u32 s56, s56, s57
    s_lshl_b32 s56, s56, 12
    s_lshl_b32 s57, s80, 7
    s_add_u32 s56, s56, s57
    s_add_u32 s59, s56, 32768
sp_48:
    ds_read_b32 v20, v18 offset:176
    s_waitcnt lgkmcnt(0)
    v_cmp_eq_u32 vcc, 1, v20
    s_cbranch_vccnz sp_48_d
    s_sleep 4
    s_add_u32 s72, s72, 1
    s_cmp_lt_u32 s72, 0x80000
    s_cbranch_scc1 sp_48
sp_48_d:
    s_mov_b32 s79, 0
K_sp:
    buffer_load_dwordx4 v[64:67], v10, s[40:43], s56 offen sc1
    buffer_load_dwordx4 v[68:71], v10, s[40:43], s59 offen sc1
    s_waitcnt vmcnt(0)
    v_max3_u32 v12, v64, v65, v66
    v_max3_u32 v13, v67, v68, v69
    v_max3_u32 v12, v12, v70, v71
    v_max_u32 v12, v12, v13
    v_cmp_eq_u32 vcc, -1, v12
    s_cbranch_vccz K_spd
    s_sleep 4
    s_add_u32 s79, s79, 1
    s_cmp_lt_u32 s79, 0x1000
    s_cbranch_scc1 K_sp
K_spd:
    ds_write_b128 v11, v[64:67]
    ds_write_b128 v11, v[68:71] offset:1024
    ds_write_b32 v18, v17 offset:160
    s_endpgm
K_end:
    s_endpgm
CODE_END:
.section .rodata,"a"
.p2align 6
.amdhsa_kernel recurrent_scan__ssm_conv_s4__mixer_channel_mlp__prompt_kernel
  .amdhsa_next_free_vgpr 256
  .amdhsa_next_free_sgpr 102
  .amdhsa_accum_offset 256
  .amdhsa_group_segment_fixed_size 0
  .amdhsa_kernarg_size 136
  .amdhsa_user_sgpr_count 2
  .amdhsa_user_sgpr_kernarg_segment_ptr 1
  .amdhsa_system_sgpr_workgroup_id_x 1
.end_amdhsa_kernel
```
